```python
import torch

def _softmax(x, axis=-1):
    return torch.softmax(x, dim=axis)
def _gelu(x):
    return torch.nn.functional.gelu(x, approximate="tanh")
def _silu(x):
    return torch.nn.functional.silu(x)
def _sigmoid(x):
    return torch.sigmoid(x)
def _layernorm(x, axis=-1, eps=1e-5):
    m = x.mean(dim=axis, keepdim=True)
    v = x.var(dim=axis, keepdim=True, unbiased=False)
    return (x - m) / torch.sqrt(v + eps)
def _scatter_add(tgt, idx, src, axis=0):
    return tgt.clone().index_add_(axis, idx, src)
def _segment_sum(src, seg, n):
    out = torch.zeros((n,) + src.shape[1:], dtype=src.dtype)
    return out.index_add_(0, seg, src)
def _pad(x, pw):
    flat = tuple(v for pair in reversed(pw) for v in pair)
    return torch.nn.functional.pad(x, flat)

kernel_name = 'gated_mix__mha_block__dense_activation_silu__prompt'

def setup_inputs():

    _w = (lambda a: (lambda t: t.to(torch.bfloat16) if t.is_floating_point() else t)(torch.as_tensor(a)))
    def _A_setup():
        B, S, D, H = 1, 2048, 512, 32
        return {
            "x": _w((lambda *s: torch.randn(*s, dtype=torch.bfloat16) * 0.05)(B, S, D)),
            "wqkv": _w((lambda *s: torch.randn(*s, dtype=torch.bfloat16) * 0.8)(D, 3 * D)),
            "wo": _w((lambda *s: torch.randn(*s, dtype=torch.bfloat16) * 0.05)(D, D)),
        }
    _A_in = _A_setup()

    def _B_setup():
        B, S, D, F = 1, 2048, 512, 1376
        return {
            "x": _w((lambda *s: torch.randn(*s, dtype=torch.bfloat16) * 0.05)(B, S, D)),
            "w1": _w((lambda *s: torch.randn(*s, dtype=torch.bfloat16) * 3.2)(D, F) * (D ** -0.5)),
            "w2": _w((lambda *s: torch.randn(*s, dtype=torch.bfloat16) * 0.8)(F, D) * (F ** -0.5)),
        }
    _B_in = _B_setup()

    return {
        "A_x": _A_in["x"],
        "A_wqkv": _A_in["wqkv"],
        "A_wo": _A_in["wo"],
        "B_x": _B_in["x"],
        "B_w1": _B_in["w1"],
        "B_w2": _B_in["w2"],
        "gate_w": _w((lambda *s: torch.randn(*s, dtype=torch.bfloat16) * 0.05)(512) * 16.0),
    }

def reference(A_x, A_wqkv, A_wo, B_x, B_w1, B_w2, gate_w):
    def _A_ref(x, wqkv, wo):
        B, S, D = x.shape
        H = 32
        Dh = D // H
        qkv = (lambda x, *d: x.permute(*d))((x @ wqkv).reshape(B, S, 3, H, Dh), 2, 0, 3, 1, 4)
        q, k, v = qkv[0], qkv[1], qkv[2]
        scores = torch.einsum("bhqd,bhkd->bhqk", q, k) * (Dh ** -0.5)
        p = _softmax(scores, axis=-1)
        o = torch.einsum("bhqk,bhkd->bhqd", p, v)
        return (lambda x, *d: x.permute(*d))(o, 0, 2, 1, 3).reshape(B, S, D) @ wo

    def _B_ref(x, w1, w2):
        h = torch.einsum("bsd,df->bsf", x, w1)
        h = _silu(h)
        out = torch.einsum("bsf,fd->bsd", h, w2)
        return out

    x = A_x
    g = _sigmoid((x * gate_w).sum(-1, keepdims=True))
    a = _A_ref(x, A_wqkv, A_wo)
    b = _B_ref(x, B_w1, B_w2)
    return g * a + (1 - g) * b
```

```asm
; @launch grid=(256,1,1) block=(512,1,1) lds=163840
.amdgcn_target "amdgcn-amd-amdhsa--gfx950"
.text
.globl gated_mix__mha_block__dense_activation_silu__prompt_kernel
.p2align 8
.type gated_mix__mha_block__dense_activation_silu__prompt_kernel,@function
gated_mix__mha_block__dense_activation_silu__prompt_kernel:
    s_cmp_ge_u32 s2, 256
    s_cbranch_scc1 gated_mix__mha_block__dense_activation_silu__prompt_kernel_exit
    s_load_dwordx2 s[8:9], s[0:1], 0
    s_load_dwordx2 s[12:13], s[0:1], 8
    s_load_dwordx2 s[28:29], s[0:1], 72
    s_load_dwordx2 s[16:17], s[0:1], 32
    s_load_dwordx2 s[20:21], s[0:1], 40
    s_load_dwordx2 s[24:25], s[0:1], 16
    s_load_dwordx2 s[32:33], s[0:1], 56
    s_load_dwordx2 s[36:37], s[0:1], 48
    v_lshrrev_b32 v1, 6, v0
    v_and_b32 v250, 63, v0
    v_readfirstlane_b32 s40, v1
    s_and_b32 s41, s2, 3
    s_lshl_b32 s41, s41, 2
    s_bfe_u32 s49, s2, 0x20003
    s_add_u32 s41, s41, s49
    s_bfe_u32 s42, s2, 0x10002
    s_lshl_b32 s42, s42, 3
    s_lshr_b32 s46, s2, 5
    s_add_u32 s42, s42, s46
    s_mov_b32 s3, s42
    s_mov_b32 s10, 0x200000
    s_mov_b32 s11, 0x00020000
    s_mov_b32 s14, 0x180000
    s_mov_b32 s15, 0x00020000
    s_cmp_lt_u32 s40, 4
    s_cbranch_scc1 gated_mix__mha_block__dense_activation_silu__prompt_kernel_cons
    s_sub_u32 s63, s40, 4
    v_lshrrev_b32 v3, 3, v250
    s_lshl_b32 s49, s41, 7
    s_lshl_b32 s50, s63, 5
    s_add_u32 s49, s49, s50
    v_add_u32 v3, s49, v3
    v_lshlrev_b32 v3, 10, v3
    v_lshrrev_b32 v4, 4, v250
    v_and_b32 v5, 7, v250
    v_xor_b32 v6, v4, v5
    v_lshlrev_b32 v6, 4, v6
    v_xor_b32 v7, 64, v6
    v_add_u32 v10, v3, v6
    v_add_u32 v7, v3, v7
    v_add_u32 v11, 0x2000, v7
    v_add_u32 v12, 0x4000, v10
    v_add_u32 v13, 0x6000, v7
    s_bfe_u32 s54, s42, 0x10002
    s_bfe_u32 s49, s41, 0x10001
    s_add_u32 s54, s54, s49
    s_lshl_b32 s54, s54, 2
    s_lshl_b32 s55, s63, 12
    s_lshl_b32 s56, s63, 10
    s_waitcnt lgkmcnt(0)
    s_add_u32 s4, s28, 0xf00000
    s_addc_u32 s5, s29, 0
    s_load_dwordx2 s[58:59], s[4:5], 0
    s_add_u32 s51, s54, 0
    s_and_b32 s51, s51, 7
    s_lshl_b32 s49, s51, 7
    s_add_u32 m0, s55, 0
    s_nop 0
    buffer_load_dwordx4 v10, s[8:11], s49 offen lds
    s_add_u32 m0, s55, 1024
    s_nop 0
    buffer_load_dwordx4 v11, s[8:11], s49 offen lds
    s_add_u32 m0, s55, 2048
    s_nop 0
    buffer_load_dwordx4 v12, s[8:11], s49 offen lds
    s_add_u32 m0, s55, 3072
    s_nop 0
    buffer_load_dwordx4 v13, s[8:11], s49 offen lds
    v_lshrrev_b32 v3, 2, v250
    s_lshl_b32 s49, s63, 4
    v_add_u32 v3, s49, v3
    v_and_b32 v4, 3, v250
    v_lshlrev_b32 v4, 4, v4
    v_mul_u32_u24 v3, 3072, v3
    s_lshl_b32 s49, s3, 6
    v_add_u32 v3, v3, v4
    v_add_u32 v14, s49, v3
    s_add_u32 s51, s54, 0
    s_and_b32 s51, s51, 7
    s_mul_i32 s50, s51, 196608
    s_add_u32 m0, s56, 86016
    s_nop 0
    buffer_load_dwordx4 v14, s[12:15], s50 offen lds
    s_add_u32 m0, s56, 90112
    s_add_u32 s50, s50, 1024
    buffer_load_dwordx4 v14, s[12:15], s50 offen lds
    s_add_u32 m0, s56, 94208
    s_add_u32 s50, s50, 1024
    buffer_load_dwordx4 v14, s[12:15], s50 offen lds
    v_lshlrev_b32 v251, 4, v250
    v_lshlrev_b32 v246, 3, v250
    v_mov_b32 v242, 0
    v_mov_b32 v243, 0
    v_mov_b32 v241, 0
    s_bfe_u32 s49, s2, 0x20003
    s_and_b32 s50, s2, 7
    s_lshl_b32 s50, s50, 2
    s_add_u32 s45, s50, s49
    s_bfe_u32 s44, s2, 0x30003
    s_lshr_b32 s43, s2, 6
    s_lshl_b32 s43, s43, 2
    s_and_b32 s51, s2, 3
    s_add_u32 s43, s43, s51
    s_bfe_u32 s51, s2, 0x10002
    s_lshl_b32 s51, s51, 4
    s_add_u32 s43, s43, s51
    s_mov_b32 s18, 0x158000
    s_mov_b32 s19, 0x00020000
    s_mov_b32 s30, 0xf10000
    s_mov_b32 s31, 0x00020000
    s_mov_b32 s22, 0x158000
    s_mov_b32 s23, 0x00020000
    s_mov_b32 s26, 0x80000
    s_mov_b32 s27, 0x00020000
    s_mov_b32 s34, 0x200000
    s_mov_b32 s35, 0x00020000
    s_mov_b32 s38, 0x400
    s_mov_b32 s39, 0x00020000
    v_lshrrev_b32 v3, 2, v250
    s_lshl_b32 s49, s63, 4
    v_add_u32 v3, s49, v3
    v_and_b32 v4, 3, v250
    v_lshlrev_b32 v4, 4, v4
    v_mul_u32_u24 v3, 2752, v3
    s_mul_i32 s49, s42, 192
    v_add_u32 v3, v3, v4
    v_add_u32 v17, s49, v3
    s_waitcnt lgkmcnt(0)
    s_add_u32 s47, s58, 1
    s_mov_b32 s48, s59
    v_mov_b32 v248, s47
    v_mov_b32 v249, s48
    v_mov_b32 v247, 0
    s_waitcnt vmcnt(3)
    s_add_u32 s51, s54, 1
    s_and_b32 s51, s51, 7
    s_lshl_b32 s49, s51, 7
    s_add_u32 m0, s55, 16384
    s_nop 0
    buffer_load_dwordx4 v10, s[8:11], s49 offen lds
    s_add_u32 m0, s55, 17408
    s_nop 0
    buffer_load_dwordx4 v11, s[8:11], s49 offen lds
    s_add_u32 m0, s55, 18432
    s_nop 0
    buffer_load_dwordx4 v12, s[8:11], s49 offen lds
    s_add_u32 m0, s55, 19456
    s_nop 0
    buffer_load_dwordx4 v13, s[8:11], s49 offen lds
    s_add_u32 s51, s54, 1
    s_and_b32 s51, s51, 7
    s_mul_i32 s50, s51, 196608
    s_add_u32 m0, s56, 98304
    s_nop 0
    buffer_load_dwordx4 v14, s[12:15], s50 offen lds
    s_add_u32 m0, s56, 102400
    s_add_u32 s50, s50, 1024
    buffer_load_dwordx4 v14, s[12:15], s50 offen lds
    s_add_u32 m0, s56, 106496
    s_add_u32 s50, s50, 1024
    buffer_load_dwordx4 v14, s[12:15], s50 offen lds
    s_waitcnt vmcnt(7)
    s_barrier
    s_add_u32 s51, s54, 2
    s_and_b32 s51, s51, 7
    s_lshl_b32 s49, s51, 7
    s_add_u32 m0, s55, 32768
    s_nop 0
    buffer_load_dwordx4 v10, s[8:11], s49 offen lds
    s_add_u32 m0, s55, 33792
    s_nop 0
    buffer_load_dwordx4 v11, s[8:11], s49 offen lds
    s_add_u32 m0, s55, 34816
    s_nop 0
    buffer_load_dwordx4 v12, s[8:11], s49 offen lds
    s_add_u32 m0, s55, 35840
    s_nop 0
    buffer_load_dwordx4 v13, s[8:11], s49 offen lds
    s_add_u32 s51, s54, 2
    s_and_b32 s51, s51, 7
    s_mul_i32 s50, s51, 196608
    s_add_u32 m0, s56, 110592
    s_nop 0
    buffer_load_dwordx4 v14, s[12:15], s50 offen lds
    s_add_u32 m0, s56, 114688
    s_add_u32 s50, s50, 1024
    buffer_load_dwordx4 v14, s[12:15], s50 offen lds
    s_add_u32 m0, s56, 118784
    s_add_u32 s50, s50, 1024
    buffer_load_dwordx4 v14, s[12:15], s50 offen lds
    s_add_u32 s51, s54, 3
    s_and_b32 s51, s51, 7
    s_lshl_b32 s49, s51, 7
    s_add_u32 m0, s55, 49152
    s_nop 0
    buffer_load_dwordx4 v10, s[8:11], s49 offen lds
    s_add_u32 m0, s55, 50176
    s_nop 0
    buffer_load_dwordx4 v11, s[8:11], s49 offen lds
    s_add_u32 m0, s55, 51200
    s_nop 0
    buffer_load_dwordx4 v12, s[8:11], s49 offen lds
    s_add_u32 m0, s55, 52224
    s_nop 0
    buffer_load_dwordx4 v13, s[8:11], s49 offen lds
    s_add_u32 s51, s54, 3
    s_and_b32 s51, s51, 7
    s_mul_i32 s50, s51, 196608
    s_add_u32 m0, s56, 122880
    s_nop 0
    buffer_load_dwordx4 v14, s[12:15], s50 offen lds
    s_add_u32 m0, s56, 126976
    s_add_u32 s50, s50, 1024
    buffer_load_dwordx4 v14, s[12:15], s50 offen lds
    s_add_u32 m0, s56, 131072
    s_add_u32 s50, s50, 1024
    buffer_load_dwordx4 v14, s[12:15], s50 offen lds
    s_lshl_b32 s49, s44, 3
    s_add_u32 s49, s49, s63
    s_add_u32 s49, s49, 0
    s_lshl_b32 s49, s49, 5
    s_add_u32 s49, s49, s43
    s_mov_b32 s96, s49
    s_lshl_b32 s49, s49, 10
    buffer_load_dwordx4 v[20:23], v251, s[8:11], s49 offen
    s_lshl_b32 s49, s44, 3
    s_add_u32 s49, s49, s63
    s_add_u32 s49, s49, 4
    s_lshl_b32 s49, s49, 5
    s_add_u32 s49, s49, s43
    s_mov_b32 s97, s49
    s_lshl_b32 s49, s49, 10
    buffer_load_dwordx4 v[24:27], v251, s[8:11], s49 offen
    buffer_load_dwordx4 v[28:31], v251, s[36:39], 0 offen
    s_waitcnt vmcnt(17)
    s_barrier
    s_add_u32 s51, s54, 4
    s_and_b32 s51, s51, 7
    s_lshl_b32 s49, s51, 7
    s_add_u32 m0, s55, 65536
    s_nop 0
    buffer_load_dwordx4 v10, s[8:11], s49 offen lds
    s_add_u32 m0, s55, 66560
    s_nop 0
    buffer_load_dwordx4 v11, s[8:11], s49 offen lds
    s_add_u32 m0, s55, 67584
    s_nop 0
    buffer_load_dwordx4 v12, s[8:11], s49 offen lds
    s_add_u32 m0, s55, 68608
    s_nop 0
    buffer_load_dwordx4 v13, s[8:11], s49 offen lds
    s_add_u32 s51, s54, 4
    s_and_b32 s51, s51, 7
    s_mul_i32 s50, s51, 196608
    s_add_u32 m0, s56, 135168
    s_nop 0
    buffer_load_dwordx4 v14, s[12:15], s50 offen lds
    s_add_u32 m0, s56, 139264
    s_add_u32 s50, s50, 1024
    buffer_load_dwordx4 v14, s[12:15], s50 offen lds
    s_add_u32 m0, s56, 143360
    s_add_u32 s50, s50, 1024
    buffer_load_dwordx4 v14, s[12:15], s50 offen lds
    s_waitcnt vmcnt(17)
    s_barrier
    s_add_u32 s51, s54, 5
    s_and_b32 s51, s51, 7
    s_lshl_b32 s49, s51, 7
    s_add_u32 m0, s55, 0
    s_nop 0
    buffer_load_dwordx4 v10, s[8:11], s49 offen lds
    s_add_u32 m0, s55, 1024
    s_nop 0
    buffer_load_dwordx4 v11, s[8:11], s49 offen lds
    s_add_u32 m0, s55, 2048
    s_nop 0
    buffer_load_dwordx4 v12, s[8:11], s49 offen lds
    s_add_u32 m0, s55, 3072
    s_nop 0
    buffer_load_dwordx4 v13, s[8:11], s49 offen lds
    s_add_u32 s51, s54, 5
    s_and_b32 s51, s51, 7
    s_mul_i32 s50, s51, 196608
    s_add_u32 m0, s56, 86016
    s_nop 0
    buffer_load_dwordx4 v14, s[12:15], s50 offen lds
    s_add_u32 m0, s56, 90112
    s_add_u32 s50, s50, 1024
    buffer_load_dwordx4 v14, s[12:15], s50 offen lds
    s_add_u32 m0, s56, 94208
    s_add_u32 s50, s50, 1024
    buffer_load_dwordx4 v14, s[12:15], s50 offen lds
    s_waitcnt vmcnt(17)
    s_barrier
    s_add_u32 s51, s54, 6
    s_and_b32 s51, s51, 7
    s_lshl_b32 s49, s51, 7
    s_add_u32 m0, s55, 16384
    s_nop 0
    buffer_load_dwordx4 v10, s[8:11], s49 offen lds
    s_add_u32 m0, s55, 17408
    s_nop 0
    buffer_load_dwordx4 v11, s[8:11], s49 offen lds
    s_add_u32 m0, s55, 18432
    s_nop 0
    buffer_load_dwordx4 v12, s[8:11], s49 offen lds
    s_add_u32 m0, s55, 19456
    s_nop 0
    buffer_load_dwordx4 v13, s[8:11], s49 offen lds
    s_add_u32 s51, s54, 6
    s_and_b32 s51, s51, 7
    s_mul_i32 s50, s51, 196608
    s_add_u32 m0, s56, 98304
    s_nop 0
    buffer_load_dwordx4 v14, s[12:15], s50 offen lds
    s_add_u32 m0, s56, 102400
    s_add_u32 s50, s50, 1024
    buffer_load_dwordx4 v14, s[12:15], s50 offen lds
    s_add_u32 m0, s56, 106496
    s_add_u32 s50, s50, 1024
    buffer_load_dwordx4 v14, s[12:15], s50 offen lds
    s_waitcnt vmcnt(21)
    v_mov_b32 v32, 0
    v_dot2_f32_bf16 v32, v20, v28, v32
    v_dot2_f32_bf16 v32, v21, v29, v32
    v_dot2_f32_bf16 v32, v22, v30, v32
    v_dot2_f32_bf16 v32, v23, v31, v32
    v_mov_b32 v33, 0
    v_dot2_f32_bf16 v33, v24, v28, v33
    v_dot2_f32_bf16 v33, v25, v29, v33
    v_dot2_f32_bf16 v33, v26, v30, v33
    v_dot2_f32_bf16 v33, v27, v31, v33
    s_nop 2
    s_nop 0
    v_add_f32_dpp v32, v32, v32 row_shr:1 row_mask:0xf bank_mask:0xf bound_ctrl:0
    v_add_f32_dpp v33, v33, v33 row_shr:1 row_mask:0xf bank_mask:0xf bound_ctrl:0
    s_nop 0
    v_add_f32_dpp v32, v32, v32 row_shr:2 row_mask:0xf bank_mask:0xf bound_ctrl:0
    v_add_f32_dpp v33, v33, v33 row_shr:2 row_mask:0xf bank_mask:0xf bound_ctrl:0
    s_nop 0
    v_add_f32_dpp v32, v32, v32 row_shr:4 row_mask:0xf bank_mask:0xf bound_ctrl:0
    v_add_f32_dpp v33, v33, v33 row_shr:4 row_mask:0xf bank_mask:0xf bound_ctrl:0
    s_nop 0
    v_add_f32_dpp v32, v32, v32 row_shr:8 row_mask:0xf bank_mask:0xf bound_ctrl:0
    v_add_f32_dpp v33, v33, v33 row_shr:8 row_mask:0xf bank_mask:0xf bound_ctrl:0
    s_nop 0
    v_add_f32_dpp v32, v32, v32 row_bcast:15 row_mask:0xa bank_mask:0xf
    v_add_f32_dpp v33, v33, v33 row_bcast:15 row_mask:0xa bank_mask:0xf
    s_nop 0
    v_add_f32_dpp v32, v32, v32 row_bcast:31 row_mask:0xc bank_mask:0xf
    v_add_f32_dpp v33, v33, v33 row_bcast:31 row_mask:0xc bank_mask:0xf
    v_mul_f32 v32, 0xbfb8aa3b, v32
    v_mul_f32 v33, 0xbfb8aa3b, v33
    v_exp_f32 v32, v32
    v_exp_f32 v33, v33
    s_nop 0
    v_add_f32 v32, 1.0, v32
    v_add_f32 v33, 1.0, v33
    v_rcp_f32 v32, v32
    v_rcp_f32 v33, v33
    s_mov_b32 exec_lo, 0
    s_mov_b32 exec_hi, 0x80000000
    s_lshl_b32 s49, s96, 2
    s_add_u32 s49, s49, 0x800000
    buffer_store_dword v32, v247, s[28:31], s49 offen sc1
    s_lshl_b32 s49, s97, 2
    s_add_u32 s49, s49, 0x800000
    buffer_store_dword v33, v247, s[28:31], s49 offen sc1
    s_mov_b64 exec, -1
    s_waitcnt vmcnt(16)
    s_barrier
    s_add_u32 s51, s54, 7
    s_and_b32 s51, s51, 7
    s_lshl_b32 s49, s51, 7
    s_add_u32 m0, s55, 32768
    s_nop 0
    buffer_load_dwordx4 v10, s[8:11], s49 offen lds
    s_add_u32 m0, s55, 33792
    s_nop 0
    buffer_load_dwordx4 v11, s[8:11], s49 offen lds
    s_add_u32 m0, s55, 34816
    s_nop 0
    buffer_load_dwordx4 v12, s[8:11], s49 offen lds
    s_add_u32 m0, s55, 35840
    s_nop 0
    buffer_load_dwordx4 v13, s[8:11], s49 offen lds
    s_add_u32 s51, s54, 7
    s_and_b32 s51, s51, 7
    s_mul_i32 s50, s51, 196608
    s_add_u32 m0, s56, 110592
    s_nop 0
    buffer_load_dwordx4 v14, s[12:15], s50 offen lds
    s_add_u32 m0, s56, 114688
    s_add_u32 s50, s50, 1024
    buffer_load_dwordx4 v14, s[12:15], s50 offen lds
    s_add_u32 m0, s56, 118784
    s_add_u32 s50, s50, 1024
    buffer_load_dwordx4 v14, s[12:15], s50 offen lds
    s_waitcnt vmcnt(16)
    s_barrier
    s_add_u32 s51, s54, 8
    s_and_b32 s51, s51, 7
    s_mul_i32 s50, s51, 176128
    s_add_u32 m0, s56, 122880
    s_nop 0
    buffer_load_dwordx4 v17, s[16:19], s50 offen lds
    s_add_u32 m0, s56, 126976
    s_add_u32 s50, s50, 64
    buffer_load_dwordx4 v17, s[16:19], s50 offen lds
    s_add_u32 m0, s56, 131072
    s_add_u32 s50, s50, 64
    buffer_load_dwordx4 v17, s[16:19], s50 offen lds
    s_waitcnt vmcnt(12)
    s_barrier
    s_add_u32 s51, s54, 9
    s_and_b32 s51, s51, 7
    s_mul_i32 s50, s51, 176128
    s_add_u32 m0, s56, 135168
    s_nop 0
    buffer_load_dwordx4 v17, s[16:19], s50 offen lds
    s_add_u32 m0, s56, 139264
    s_add_u32 s50, s50, 64
    buffer_load_dwordx4 v17, s[16:19], s50 offen lds
    s_add_u32 m0, s56, 143360
    s_add_u32 s50, s50, 64
    buffer_load_dwordx4 v17, s[16:19], s50 offen lds
    s_waitcnt vmcnt(6)
    s_barrier
    s_add_u32 s51, s54, 10
    s_and_b32 s51, s51, 7
    s_mul_i32 s50, s51, 176128
    s_add_u32 m0, s56, 86016
    s_nop 0
    buffer_load_dwordx4 v17, s[16:19], s50 offen lds
    s_add_u32 m0, s56, 90112
    s_add_u32 s50, s50, 64
    buffer_load_dwordx4 v17, s[16:19], s50 offen lds
    s_add_u32 m0, s56, 94208
    s_add_u32 s50, s50, 64
    buffer_load_dwordx4 v17, s[16:19], s50 offen lds
    s_waitcnt vmcnt(6)
    s_barrier
    s_add_u32 s51, s54, 11
    s_and_b32 s51, s51, 7
    s_mul_i32 s50, s51, 176128
    s_add_u32 m0, s56, 98304
    s_nop 0
    buffer_load_dwordx4 v17, s[16:19], s50 offen lds
    s_add_u32 m0, s56, 102400
    s_add_u32 s50, s50, 64
    buffer_load_dwordx4 v17, s[16:19], s50 offen lds
    s_add_u32 m0, s56, 106496
    s_add_u32 s50, s50, 64
    buffer_load_dwordx4 v17, s[16:19], s50 offen lds
    s_waitcnt vmcnt(6)
    s_barrier
    s_add_u32 s51, s54, 12
    s_and_b32 s51, s51, 7
    s_mul_i32 s50, s51, 176128
    s_add_u32 m0, s56, 110592
    s_nop 0
    buffer_load_dwordx4 v17, s[16:19], s50 offen lds
    s_add_u32 m0, s56, 114688
    s_add_u32 s50, s50, 64
    buffer_load_dwordx4 v17, s[16:19], s50 offen lds
    s_add_u32 m0, s56, 118784
    s_add_u32 s50, s50, 64
    buffer_load_dwordx4 v17, s[16:19], s50 offen lds
    s_waitcnt vmcnt(6)
    s_barrier
    s_add_u32 s51, s54, 13
    s_and_b32 s51, s51, 7
    s_mul_i32 s50, s51, 176128
    s_add_u32 m0, s56, 122880
    s_nop 0
    buffer_load_dwordx4 v17, s[16:19], s50 offen lds
    s_add_u32 m0, s56, 126976
    s_add_u32 s50, s50, 64
    buffer_load_dwordx4 v17, s[16:19], s50 offen lds
    s_add_u32 m0, s56, 131072
    s_add_u32 s50, s50, 64
    buffer_load_dwordx4 v17, s[16:19], s50 offen lds
    s_waitcnt vmcnt(6)
    s_barrier
    s_add_u32 s51, s54, 14
    s_and_b32 s51, s51, 7
    s_mul_i32 s50, s51, 176128
    s_add_u32 m0, s56, 135168
    s_nop 0
    buffer_load_dwordx4 v17, s[16:19], s50 offen lds
    s_add_u32 m0, s56, 139264
    s_add_u32 s50, s50, 64
    buffer_load_dwordx4 v17, s[16:19], s50 offen lds
    s_add_u32 m0, s56, 143360
    s_add_u32 s50, s50, 64
    buffer_load_dwordx4 v17, s[16:19], s50 offen lds
    s_waitcnt vmcnt(6)
    s_barrier
    s_add_u32 s51, s54, 15
    s_and_b32 s51, s51, 7
    s_mul_i32 s50, s51, 176128
    s_add_u32 m0, s56, 86016
    s_nop 0
    buffer_load_dwordx4 v17, s[16:19], s50 offen lds
    s_add_u32 m0, s56, 90112
    s_add_u32 s50, s50, 64
    buffer_load_dwordx4 v17, s[16:19], s50 offen lds
    s_add_u32 m0, s56, 94208
    s_add_u32 s50, s50, 64
    buffer_load_dwordx4 v17, s[16:19], s50 offen lds
    s_waitcnt vmcnt(6)
    s_barrier
    s_waitcnt vmcnt(3)
    s_barrier
    s_waitcnt vmcnt(0)
    s_barrier
    s_lshr_b32 s54, s43, 1
    s_lshl_b32 s54, s54, 9
    s_add_u32 s54, s54, 0xf01000
    buffer_load_dwordx2 v[244:245], v246, s[28:31], s54 offen sc1
    s_mov_b32 s62, 0
L1_spin:
    s_waitcnt vmcnt(0)
L3_look:
    v_cmp_eq_u32 vcc, s47, v244
    v_cmp_eq_u32 s[4:5], s48, v245
    s_nop 1
    s_and_b64 vcc, vcc, s[4:5]
    s_cmp_eq_u64 vcc, -1
    s_cbranch_scc1 L2_matched
    s_add_u32 s62, s62, 1
    s_cmp_ge_u32 s62, 131072
    s_cbranch_scc1 L2_matched
    buffer_load_dwordx2 v[244:245], v246, s[28:31], s54 offen sc1
    s_branch L1_spin
L2_matched:
    s_lshl_b32 s50, s43, 16
    s_lshl_b32 s49, s44, 13
    s_add_u32 s49, s49, s50
    s_lshl_b32 s51, s63, 11
    s_add_u32 s49, s49, s51
    s_add_u32 s49, s49, 0x0
    s_add_u32 m0, s51, 147456
    s_nop 0
    buffer_load_dwordx4 v251, s[28:31], s49 offen sc1 lds
    s_lshl_b32 s49, s44, 13
    s_add_u32 s49, s49, s50
    s_lshl_b32 s51, s63, 11
    s_add_u32 s49, s49, s51
    s_add_u32 s49, s49, 0x400
    s_add_u32 m0, s51, 148480
    s_nop 0
    buffer_load_dwordx4 v251, s[28:31], s49 offen sc1 lds
    s_lshl_b32 s96, s63, 10
    s_add_u32 s97, s50, s96
    s_add_u32 s49, s97, 0x200000
    s_add_u32 m0, s96, 0
    s_add_u32 s52, s97, 0x400000
    buffer_load_dwordx4 v251, s[28:31], s49 offen sc1 lds
    s_add_u32 m0, s96, 65536
    s_nop 0
    buffer_load_dwordx4 v251, s[28:31], s52 offen sc1 lds
    s_add_u32 s49, s97, 0x201000
    s_add_u32 m0, s96, 4096
    s_add_u32 s52, s97, 0x401000
    buffer_load_dwordx4 v251, s[28:31], s49 offen sc1 lds
    s_add_u32 m0, s96, 69632
    s_nop 0
    buffer_load_dwordx4 v251, s[28:31], s52 offen sc1 lds
    s_add_u32 s49, s97, 0x202000
    s_add_u32 m0, s96, 8192
    s_add_u32 s52, s97, 0x402000
    buffer_load_dwordx4 v251, s[28:31], s49 offen sc1 lds
    s_add_u32 m0, s96, 73728
    s_nop 0
    buffer_load_dwordx4 v251, s[28:31], s52 offen sc1 lds
    s_add_u32 s49, s97, 0x203000
    s_add_u32 m0, s96, 12288
    s_add_u32 s52, s97, 0x403000
    buffer_load_dwordx4 v251, s[28:31], s49 offen sc1 lds
    s_add_u32 m0, s96, 77824
    s_nop 0
    buffer_load_dwordx4 v251, s[28:31], s52 offen sc1 lds
    s_add_u32 s49, s97, 0x204000
    s_add_u32 m0, s96, 16384
    s_add_u32 s52, s97, 0x404000
    buffer_load_dwordx4 v251, s[28:31], s49 offen sc1 lds
    s_add_u32 m0, s96, 81920
    s_nop 0
    buffer_load_dwordx4 v251, s[28:31], s52 offen sc1 lds
    s_branch L4_join
gated_mix__mha_block__dense_activation_silu__prompt_kernel_cons:
    v_lshlrev_b32 v251, 4, v250
    v_lshlrev_b32 v246, 3, v250
    v_mov_b32 v242, 0
    v_mov_b32 v243, 0
    v_mov_b32 v241, 0
    s_bfe_u32 s49, s2, 0x20003
    s_and_b32 s50, s2, 7
    s_lshl_b32 s50, s50, 2
    s_add_u32 s45, s50, s49
    s_bfe_u32 s44, s2, 0x30003
    s_lshr_b32 s43, s2, 6
    s_lshl_b32 s43, s43, 2
    s_and_b32 s51, s2, 3
    s_add_u32 s43, s43, s51
    s_bfe_u32 s51, s2, 0x10002
    s_lshl_b32 s51, s51, 4
    s_add_u32 s43, s43, s51
    s_mov_b32 s18, 0x158000
    s_mov_b32 s19, 0x00020000
    s_mov_b32 s30, 0xf10000
    s_mov_b32 s31, 0x00020000
    s_mov_b32 s22, 0x158000
    s_mov_b32 s23, 0x00020000
    s_mov_b32 s26, 0x80000
    s_mov_b32 s27, 0x00020000
    s_mov_b32 s34, 0x200000
    s_mov_b32 s35, 0x00020000
    s_mov_b32 s38, 0x400
    s_mov_b32 s39, 0x00020000
    v_and_b32 v3, 31, v250
    v_lshrrev_b32 v4, 5, v250
    v_lshrrev_b32 v5, 1, v3
    v_and_b32 v5, 7, v5
    s_lshl_b32 s49, s40, 5
    v_add_u32 v3, s49, v3
    v_lshlrev_b32 v3, 7, v3
    v_add_u32 v6, 0, v4
    v_xor_b32 v6, v6, v5
    v_lshlrev_b32 v6, 4, v6
    v_add_u32 v200, v3, v6
    v_add_u32 v204, 0x10000, v200
    v_add_u32 v6, 2, v4
    v_xor_b32 v6, v6, v5
    v_lshlrev_b32 v6, 4, v6
    v_add_u32 v201, v3, v6
    v_add_u32 v205, 0x10000, v201
    v_add_u32 v6, 4, v4
    v_xor_b32 v6, v6, v5
    v_lshlrev_b32 v6, 4, v6
    v_add_u32 v202, v3, v6
    v_add_u32 v206, 0x10000, v202
    v_add_u32 v6, 6, v4
    v_xor_b32 v6, v6, v5
    v_lshlrev_b32 v6, 4, v6
    v_add_u32 v203, v3, v6
    v_add_u32 v207, 0x10000, v203
    v_lshlrev_b32 v3, 3, v4
    v_bfe_u32 v5, v250, 2, 2
    v_add_u32 v3, v3, v5
    v_lshlrev_b32 v3, 6, v3
    v_bfe_u32 v5, v250, 4, 1
    v_lshlrev_b32 v5, 5, v5
    v_add_u32 v3, v3, v5
    v_and_b32 v5, 3, v250
    v_lshlrev_b32 v5, 3, v5
    v_add_u32 v3, v3, v5
    v_add_u32 v236, 86016, v3
    v_bfe_u32 v237, v250, 4, 1
    v_lshlrev_b32 v237, 16, v237
    v_lshlrev_b32 v238, 8, v4
    v_add_u32 v237, v237, v238
    v_and_b32 v238, 15, v250
    v_lshlrev_b32 v238, 4, v238
    v_add_u32 v237, v237, v238
    s_lshl_b32 s49, s41, 2
    s_add_u32 s49, s49, s40
    s_lshl_b32 s55, s3, 17
    s_lshl_b32 s49, s49, 10
    s_add_u32 s55, s55, s49
    s_mov_b32 s56, 0x3eb8aa3b
    s_waitcnt lgkmcnt(0)
    s_add_u32 s4, s28, 0xf00000
    s_addc_u32 s5, s29, 0
    s_load_dwordx2 s[58:59], s[4:5], 0
    s_waitcnt lgkmcnt(0)
    s_add_u32 s47, s58, 1
    s_mov_b32 s48, s59
    v_mov_b32 v248, s47
    v_mov_b32 v249, s48
    v_mov_b32 v247, 0
    s_barrier
    ds_read_b128 v[0:3], v200 offset:0
    ds_read_b64_tr_b16 v[176:177], v236 offset:0
    ds_read_b64_tr_b16 v[178:179], v236 offset:256
    ds_read_b64_tr_b16 v[180:181], v236 offset:4096
    ds_read_b64_tr_b16 v[182:183], v236 offset:4352
    ds_read_b64_tr_b16 v[184:185], v236 offset:8192
    ds_read_b64_tr_b16 v[186:187], v236 offset:8448
    s_waitcnt lgkmcnt(4)
    v_mfma_f32_32x32x16_bf16 v[128:143], v[176:179], v[0:3], 0
    ds_read_b128 v[4:7], v201 offset:0
    ds_read_b64_tr_b16 v[188:189], v236 offset:1024
    ds_read_b64_tr_b16 v[190:191], v236 offset:1280
    s_waitcnt lgkmcnt(5)
    v_mfma_f32_32x32x16_bf16 v[144:159], v[180:183], v[0:3], 0
    ds_read_b64_tr_b16 v[192:193], v236 offset:5120
    ds_read_b64_tr_b16 v[194:195], v236 offset:5376
    s_waitcnt lgkmcnt(5)
    v_mfma_f32_32x32x16_bf16 v[160:175], v[0:3], v[184:187], 0
    ds_read_b64_tr_b16 v[196:197], v236 offset:9216
    ds_read_b64_tr_b16 v[198:199], v236 offset:9472
    s_waitcnt lgkmcnt(4)
    v_mfma_f32_32x32x16_bf16 v[128:143], v[188:191], v[4:7], v[128:143]
    ds_read_b128 v[8:11], v202 offset:0
    ds_read_b64_tr_b16 v[176:177], v236 offset:2048
    ds_read_b64_tr_b16 v[178:179], v236 offset:2304
    s_waitcnt lgkmcnt(5)
    v_mfma_f32_32x32x16_bf16 v[144:159], v[192:195], v[4:7], v[144:159]
    ds_read_b64_tr_b16 v[180:181], v236 offset:6144
    ds_read_b64_tr_b16 v[182:183], v236 offset:6400
    s_waitcnt lgkmcnt(5)
    v_mfma_f32_32x32x16_bf16 v[160:175], v[4:7], v[196:199], v[160:175]
    ds_read_b64_tr_b16 v[184:185], v236 offset:10240
    ds_read_b64_tr_b16 v[186:187], v236 offset:10496
    s_barrier
    s_waitcnt lgkmcnt(4)
    v_mfma_f32_32x32x16_bf16 v[128:143], v[176:179], v[8:11], v[128:143]
    ds_read_b128 v[12:15], v203 offset:0
    ds_read_b64_tr_b16 v[188:189], v236 offset:3072
    ds_read_b64_tr_b16 v[190:191], v236 offset:3328
    s_waitcnt lgkmcnt(5)
    v_mfma_f32_32x32x16_bf16 v[144:159], v[180:183], v[8:11], v[144:159]
    ds_read_b64_tr_b16 v[192:193], v236 offset:7168
    ds_read_b64_tr_b16 v[194:195], v236 offset:7424
    s_waitcnt lgkmcnt(5)
    v_mfma_f32_32x32x16_bf16 v[160:175], v[8:11], v[184:187], v[160:175]
    ds_read_b64_tr_b16 v[196:197], v236 offset:11264
    ds_read_b64_tr_b16 v[198:199], v236 offset:11520
    s_waitcnt lgkmcnt(4)
    v_mfma_f32_32x32x16_bf16 v[128:143], v[188:191], v[12:15], v[128:143]
    ds_read_b128 v[16:19], v200 offset:16384
    ds_read_b64_tr_b16 v[176:177], v236 offset:12288
    ds_read_b64_tr_b16 v[178:179], v236 offset:12544
    s_waitcnt lgkmcnt(5)
    v_mfma_f32_32x32x16_bf16 v[144:159], v[192:195], v[12:15], v[144:159]
    ds_read_b64_tr_b16 v[180:181], v236 offset:16384
    ds_read_b64_tr_b16 v[182:183], v236 offset:16640
    s_waitcnt lgkmcnt(5)
    v_mfma_f32_32x32x16_bf16 v[160:175], v[12:15], v[196:199], v[160:175]
    ds_read_b64_tr_b16 v[184:185], v236 offset:20480
    ds_read_b64_tr_b16 v[186:187], v236 offset:20736
    s_waitcnt lgkmcnt(4)
    v_mfma_f32_32x32x16_bf16 v[128:143], v[176:179], v[16:19], v[128:143]
    ds_read_b128 v[20:23], v201 offset:16384
    ds_read_b64_tr_b16 v[188:189], v236 offset:13312
    ds_read_b64_tr_b16 v[190:191], v236 offset:13568
    s_waitcnt lgkmcnt(5)
    v_mfma_f32_32x32x16_bf16 v[144:159], v[180:183], v[16:19], v[144:159]
    ds_read_b64_tr_b16 v[192:193], v236 offset:17408
    ds_read_b64_tr_b16 v[194:195], v236 offset:17664
    s_waitcnt lgkmcnt(5)
    v_mfma_f32_32x32x16_bf16 v[160:175], v[16:19], v[184:187], v[160:175]
    ds_read_b64_tr_b16 v[196:197], v236 offset:21504
    ds_read_b64_tr_b16 v[198:199], v236 offset:21760
    s_waitcnt lgkmcnt(4)
    v_mfma_f32_32x32x16_bf16 v[128:143], v[188:191], v[20:23], v[128:143]
    ds_read_b128 v[24:27], v202 offset:16384
    ds_read_b64_tr_b16 v[176:177], v236 offset:14336
    ds_read_b64_tr_b16 v[178:179], v236 offset:14592
    s_waitcnt lgkmcnt(5)
    v_mfma_f32_32x32x16_bf16 v[144:159], v[192:195], v[20:23], v[144:159]
    ds_read_b64_tr_b16 v[180:181], v236 offset:18432
    ds_read_b64_tr_b16 v[182:183], v236 offset:18688
    s_waitcnt lgkmcnt(5)
    v_mfma_f32_32x32x16_bf16 v[160:175], v[20:23], v[196:199], v[160:175]
    ds_read_b64_tr_b16 v[184:185], v236 offset:22528
    ds_read_b64_tr_b16 v[186:187], v236 offset:22784
    s_barrier
    s_waitcnt lgkmcnt(4)
    v_mfma_f32_32x32x16_bf16 v[128:143], v[176:179], v[24:27], v[128:143]
    ds_read_b128 v[28:31], v203 offset:16384
    ds_read_b64_tr_b16 v[188:189], v236 offset:15360
    ds_read_b64_tr_b16 v[190:191], v236 offset:15616
    s_waitcnt lgkmcnt(5)
    v_mfma_f32_32x32x16_bf16 v[144:159], v[180:183], v[24:27], v[144:159]
    ds_read_b64_tr_b16 v[192:193], v236 offset:19456
    ds_read_b64_tr_b16 v[194:195], v236 offset:19712
    s_waitcnt lgkmcnt(5)
    v_mfma_f32_32x32x16_bf16 v[160:175], v[24:27], v[184:187], v[160:175]
    ds_read_b64_tr_b16 v[196:197], v236 offset:23552
    ds_read_b64_tr_b16 v[198:199], v236 offset:23808
    s_waitcnt lgkmcnt(4)
    v_mfma_f32_32x32x16_bf16 v[128:143], v[188:191], v[28:31], v[128:143]
    ds_read_b128 v[32:35], v200 offset:32768
    ds_read_b64_tr_b16 v[176:177], v236 offset:24576
    ds_read_b64_tr_b16 v[178:179], v236 offset:24832
    s_waitcnt lgkmcnt(5)
    v_mfma_f32_32x32x16_bf16 v[144:159], v[192:195], v[28:31], v[144:159]
    ds_read_b64_tr_b16 v[180:181], v236 offset:28672
    ds_read_b64_tr_b16 v[182:183], v236 offset:28928
    s_waitcnt lgkmcnt(5)
    v_mfma_f32_32x32x16_bf16 v[160:175], v[28:31], v[196:199], v[160:175]
    ds_read_b64_tr_b16 v[184:185], v236 offset:32768
    ds_read_b64_tr_b16 v[186:187], v236 offset:33024
    s_waitcnt lgkmcnt(4)
    v_mfma_f32_32x32x16_bf16 v[128:143], v[176:179], v[32:35], v[128:143]
    ds_read_b128 v[36:39], v201 offset:32768
    ds_read_b64_tr_b16 v[188:189], v236 offset:25600
    ds_read_b64_tr_b16 v[190:191], v236 offset:25856
    s_waitcnt lgkmcnt(5)
    v_mfma_f32_32x32x16_bf16 v[144:159], v[180:183], v[32:35], v[144:159]
    ds_read_b64_tr_b16 v[192:193], v236 offset:29696
    ds_read_b64_tr_b16 v[194:195], v236 offset:29952
    s_waitcnt lgkmcnt(5)
    v_mfma_f32_32x32x16_bf16 v[160:175], v[32:35], v[184:187], v[160:175]
    ds_read_b64_tr_b16 v[196:197], v236 offset:33792
    ds_read_b64_tr_b16 v[198:199], v236 offset:34048
    s_waitcnt lgkmcnt(4)
    v_mfma_f32_32x32x16_bf16 v[128:143], v[188:191], v[36:39], v[128:143]
    ds_read_b128 v[40:43], v202 offset:32768
    ds_read_b64_tr_b16 v[176:177], v236 offset:26624
    ds_read_b64_tr_b16 v[178:179], v236 offset:26880
    s_waitcnt lgkmcnt(5)
    v_mfma_f32_32x32x16_bf16 v[144:159], v[192:195], v[36:39], v[144:159]
    ds_read_b64_tr_b16 v[180:181], v236 offset:30720
    ds_read_b64_tr_b16 v[182:183], v236 offset:30976
    s_waitcnt lgkmcnt(5)
    v_mfma_f32_32x32x16_bf16 v[160:175], v[36:39], v[196:199], v[160:175]
    ds_read_b64_tr_b16 v[184:185], v236 offset:34816
    ds_read_b64_tr_b16 v[186:187], v236 offset:35072
    s_barrier
    s_waitcnt lgkmcnt(4)
    v_mfma_f32_32x32x16_bf16 v[128:143], v[176:179], v[40:43], v[128:143]
    ds_read_b128 v[44:47], v203 offset:32768
    ds_read_b64_tr_b16 v[188:189], v236 offset:27648
    ds_read_b64_tr_b16 v[190:191], v236 offset:27904
    s_waitcnt lgkmcnt(5)
    v_mfma_f32_32x32x16_bf16 v[144:159], v[180:183], v[40:43], v[144:159]
    ds_read_b64_tr_b16 v[192:193], v236 offset:31744
    ds_read_b64_tr_b16 v[194:195], v236 offset:32000
    s_waitcnt lgkmcnt(5)
    v_mfma_f32_32x32x16_bf16 v[160:175], v[40:43], v[184:187], v[160:175]
    ds_read_b64_tr_b16 v[196:197], v236 offset:35840
    ds_read_b64_tr_b16 v[198:199], v236 offset:36096
    s_waitcnt lgkmcnt(4)
    v_mfma_f32_32x32x16_bf16 v[128:143], v[188:191], v[44:47], v[128:143]
    ds_read_b128 v[48:51], v200 offset:49152
    ds_read_b64_tr_b16 v[176:177], v236 offset:36864
    ds_read_b64_tr_b16 v[178:179], v236 offset:37120
    s_waitcnt lgkmcnt(5)
    v_mfma_f32_32x32x16_bf16 v[144:159], v[192:195], v[44:47], v[144:159]
    ds_read_b64_tr_b16 v[180:181], v236 offset:40960
    ds_read_b64_tr_b16 v[182:183], v236 offset:41216
    s_waitcnt lgkmcnt(5)
    v_mfma_f32_32x32x16_bf16 v[160:175], v[44:47], v[196:199], v[160:175]
    ds_read_b64_tr_b16 v[184:185], v236 offset:45056
    ds_read_b64_tr_b16 v[186:187], v236 offset:45312
    s_waitcnt lgkmcnt(4)
    v_mfma_f32_32x32x16_bf16 v[128:143], v[176:179], v[48:51], v[128:143]
    ds_read_b128 v[52:55], v201 offset:49152
    ds_read_b64_tr_b16 v[188:189], v236 offset:37888
    ds_read_b64_tr_b16 v[190:191], v236 offset:38144
    s_waitcnt lgkmcnt(5)
    v_mfma_f32_32x32x16_bf16 v[144:159], v[180:183], v[48:51], v[144:159]
    ds_read_b64_tr_b16 v[192:193], v236 offset:41984
    ds_read_b64_tr_b16 v[194:195], v236 offset:42240
    s_waitcnt lgkmcnt(5)
    v_mfma_f32_32x32x16_bf16 v[160:175], v[48:51], v[184:187], v[160:175]
    ds_read_b64_tr_b16 v[196:197], v236 offset:46080
    ds_read_b64_tr_b16 v[198:199], v236 offset:46336
    s_waitcnt lgkmcnt(4)
    v_mfma_f32_32x32x16_bf16 v[128:143], v[188:191], v[52:55], v[128:143]
    ds_read_b128 v[56:59], v202 offset:49152
    ds_read_b64_tr_b16 v[176:177], v236 offset:38912
    ds_read_b64_tr_b16 v[178:179], v236 offset:39168
    s_waitcnt lgkmcnt(5)
    v_mfma_f32_32x32x16_bf16 v[144:159], v[192:195], v[52:55], v[144:159]
    ds_read_b64_tr_b16 v[180:181], v236 offset:43008
    ds_read_b64_tr_b16 v[182:183], v236 offset:43264
    s_waitcnt lgkmcnt(5)
    v_mfma_f32_32x32x16_bf16 v[160:175], v[52:55], v[196:199], v[160:175]
    ds_read_b64_tr_b16 v[184:185], v236 offset:47104
    ds_read_b64_tr_b16 v[186:187], v236 offset:47360
    s_barrier
    s_waitcnt lgkmcnt(4)
    v_mfma_f32_32x32x16_bf16 v[128:143], v[176:179], v[56:59], v[128:143]
    ds_read_b128 v[60:63], v203 offset:49152
    ds_read_b64_tr_b16 v[188:189], v236 offset:39936
    ds_read_b64_tr_b16 v[190:191], v236 offset:40192
    s_waitcnt lgkmcnt(5)
    v_mfma_f32_32x32x16_bf16 v[144:159], v[180:183], v[56:59], v[144:159]
    ds_read_b64_tr_b16 v[192:193], v236 offset:44032
    ds_read_b64_tr_b16 v[194:195], v236 offset:44288
    s_waitcnt lgkmcnt(5)
    v_mfma_f32_32x32x16_bf16 v[160:175], v[56:59], v[184:187], v[160:175]
    ds_read_b64_tr_b16 v[196:197], v236 offset:48128
    ds_read_b64_tr_b16 v[198:199], v236 offset:48384
    s_waitcnt lgkmcnt(4)
    v_mfma_f32_32x32x16_bf16 v[128:143], v[188:191], v[60:63], v[128:143]
    ds_read_b128 v[64:67], v204
    ds_read_b64_tr_b16 v[176:177], v236 offset:49152
    ds_read_b64_tr_b16 v[178:179], v236 offset:49408
    s_waitcnt lgkmcnt(5)
    v_mfma_f32_32x32x16_bf16 v[144:159], v[192:195], v[60:63], v[144:159]
    ds_read_b64_tr_b16 v[180:181], v236 offset:53248
    ds_read_b64_tr_b16 v[182:183], v236 offset:53504
    s_waitcnt lgkmcnt(5)
    v_mfma_f32_32x32x16_bf16 v[160:175], v[60:63], v[196:199], v[160:175]
    ds_read_b64_tr_b16 v[184:185], v236 offset:57344
    ds_read_b64_tr_b16 v[186:187], v236 offset:57600
    s_waitcnt lgkmcnt(4)
    v_mfma_f32_32x32x16_bf16 v[128:143], v[176:179], v[64:67], v[128:143]
    ds_read_b128 v[68:71], v205
    ds_read_b64_tr_b16 v[188:189], v236 offset:50176
    ds_read_b64_tr_b16 v[190:191], v236 offset:50432
    s_waitcnt lgkmcnt(5)
    v_mfma_f32_32x32x16_bf16 v[144:159], v[180:183], v[64:67], v[144:159]
    ds_read_b64_tr_b16 v[192:193], v236 offset:54272
    ds_read_b64_tr_b16 v[194:195], v236 offset:54528
    s_waitcnt lgkmcnt(5)
    v_mfma_f32_32x32x16_bf16 v[160:175], v[64:67], v[184:187], v[160:175]
    ds_read_b64_tr_b16 v[196:197], v236 offset:58368
    ds_read_b64_tr_b16 v[198:199], v236 offset:58624
    s_waitcnt lgkmcnt(4)
    v_mfma_f32_32x32x16_bf16 v[128:143], v[188:191], v[68:71], v[128:143]
    ds_read_b128 v[72:75], v206
    ds_read_b64_tr_b16 v[176:177], v236 offset:51200
    ds_read_b64_tr_b16 v[178:179], v236 offset:51456
    s_waitcnt lgkmcnt(5)
    v_mfma_f32_32x32x16_bf16 v[144:159], v[192:195], v[68:71], v[144:159]
    ds_read_b64_tr_b16 v[180:181], v236 offset:55296
    ds_read_b64_tr_b16 v[182:183], v236 offset:55552
    s_waitcnt lgkmcnt(5)
    v_mfma_f32_32x32x16_bf16 v[160:175], v[68:71], v[196:199], v[160:175]
    ds_read_b64_tr_b16 v[184:185], v236 offset:59392
    ds_read_b64_tr_b16 v[186:187], v236 offset:59648
    s_barrier
    s_waitcnt lgkmcnt(4)
    v_mfma_f32_32x32x16_bf16 v[128:143], v[176:179], v[72:75], v[128:143]
    ds_read_b128 v[76:79], v207
    ds_read_b64_tr_b16 v[188:189], v236 offset:52224
    ds_read_b64_tr_b16 v[190:191], v236 offset:52480
    s_waitcnt lgkmcnt(5)
    v_mfma_f32_32x32x16_bf16 v[144:159], v[180:183], v[72:75], v[144:159]
    ds_read_b64_tr_b16 v[192:193], v236 offset:56320
    ds_read_b64_tr_b16 v[194:195], v236 offset:56576
    s_waitcnt lgkmcnt(5)
    v_mfma_f32_32x32x16_bf16 v[160:175], v[72:75], v[184:187], v[160:175]
    ds_read_b64_tr_b16 v[196:197], v236 offset:60416
    ds_read_b64_tr_b16 v[198:199], v236 offset:60672
    s_waitcnt lgkmcnt(4)
    v_mfma_f32_32x32x16_bf16 v[128:143], v[188:191], v[76:79], v[128:143]
    ds_read_b128 v[80:83], v200 offset:0
    ds_read_b64_tr_b16 v[176:177], v236 offset:0
    ds_read_b64_tr_b16 v[178:179], v236 offset:256
    s_waitcnt lgkmcnt(5)
    v_mfma_f32_32x32x16_bf16 v[144:159], v[192:195], v[76:79], v[144:159]
    ds_read_b64_tr_b16 v[180:181], v236 offset:4096
    ds_read_b64_tr_b16 v[182:183], v236 offset:4352
    s_waitcnt lgkmcnt(5)
    v_mfma_f32_32x32x16_bf16 v[160:175], v[76:79], v[196:199], v[160:175]
    ds_read_b64_tr_b16 v[184:185], v236 offset:8192
    ds_read_b64_tr_b16 v[186:187], v236 offset:8448
    s_waitcnt lgkmcnt(4)
    v_mfma_f32_32x32x16_bf16 v[128:143], v[176:179], v[80:83], v[128:143]
    ds_read_b128 v[84:87], v201 offset:0
    ds_read_b64_tr_b16 v[188:189], v236 offset:1024
    ds_read_b64_tr_b16 v[190:191], v236 offset:1280
    s_waitcnt lgkmcnt(5)
    v_mfma_f32_32x32x16_bf16 v[144:159], v[180:183], v[80:83], v[144:159]
    ds_read_b64_tr_b16 v[192:193], v236 offset:5120
    ds_read_b64_tr_b16 v[194:195], v236 offset:5376
    s_waitcnt lgkmcnt(5)
    v_mfma_f32_32x32x16_bf16 v[160:175], v[80:83], v[184:187], v[160:175]
    ds_read_b64_tr_b16 v[196:197], v236 offset:9216
    ds_read_b64_tr_b16 v[198:199], v236 offset:9472
    s_waitcnt lgkmcnt(4)
    v_mfma_f32_32x32x16_bf16 v[128:143], v[188:191], v[84:87], v[128:143]
    ds_read_b128 v[88:91], v202 offset:0
    ds_read_b64_tr_b16 v[176:177], v236 offset:2048
    ds_read_b64_tr_b16 v[178:179], v236 offset:2304
    s_waitcnt lgkmcnt(5)
    v_mfma_f32_32x32x16_bf16 v[144:159], v[192:195], v[84:87], v[144:159]
    ds_read_b64_tr_b16 v[180:181], v236 offset:6144
    ds_read_b64_tr_b16 v[182:183], v236 offset:6400
    s_waitcnt lgkmcnt(5)
    v_mfma_f32_32x32x16_bf16 v[160:175], v[84:87], v[196:199], v[160:175]
    ds_read_b64_tr_b16 v[184:185], v236 offset:10240
    ds_read_b64_tr_b16 v[186:187], v236 offset:10496
    s_barrier
    s_waitcnt lgkmcnt(4)
    v_mfma_f32_32x32x16_bf16 v[128:143], v[176:179], v[88:91], v[128:143]
    ds_read_b128 v[92:95], v203 offset:0
    ds_read_b64_tr_b16 v[188:189], v236 offset:3072
    ds_read_b64_tr_b16 v[190:191], v236 offset:3328
    s_waitcnt lgkmcnt(5)
    v_mfma_f32_32x32x16_bf16 v[144:159], v[180:183], v[88:91], v[144:159]
    ds_read_b64_tr_b16 v[192:193], v236 offset:7168
    ds_read_b64_tr_b16 v[194:195], v236 offset:7424
    s_waitcnt lgkmcnt(5)
    v_mfma_f32_32x32x16_bf16 v[160:175], v[88:91], v[184:187], v[160:175]
    ds_read_b64_tr_b16 v[196:197], v236 offset:11264
    ds_read_b64_tr_b16 v[198:199], v236 offset:11520
    s_waitcnt lgkmcnt(4)
    v_mfma_f32_32x32x16_bf16 v[128:143], v[188:191], v[92:95], v[128:143]
    ds_read_b128 v[96:99], v200 offset:16384
    ds_read_b64_tr_b16 v[176:177], v236 offset:12288
    ds_read_b64_tr_b16 v[178:179], v236 offset:12544
    s_waitcnt lgkmcnt(5)
    v_mfma_f32_32x32x16_bf16 v[144:159], v[192:195], v[92:95], v[144:159]
    ds_read_b64_tr_b16 v[180:181], v236 offset:16384
    ds_read_b64_tr_b16 v[182:183], v236 offset:16640
    s_waitcnt lgkmcnt(5)
    v_mfma_f32_32x32x16_bf16 v[160:175], v[92:95], v[196:199], v[160:175]
    ds_read_b64_tr_b16 v[184:185], v236 offset:20480
    ds_read_b64_tr_b16 v[186:187], v236 offset:20736
    s_waitcnt lgkmcnt(4)
    v_mfma_f32_32x32x16_bf16 v[128:143], v[176:179], v[96:99], v[128:143]
    ds_read_b128 v[100:103], v201 offset:16384
    ds_read_b64_tr_b16 v[188:189], v236 offset:13312
    ds_read_b64_tr_b16 v[190:191], v236 offset:13568
    s_waitcnt lgkmcnt(5)
    v_mfma_f32_32x32x16_bf16 v[144:159], v[180:183], v[96:99], v[144:159]
    ds_read_b64_tr_b16 v[192:193], v236 offset:17408
    ds_read_b64_tr_b16 v[194:195], v236 offset:17664
    s_waitcnt lgkmcnt(5)
    v_mfma_f32_32x32x16_bf16 v[160:175], v[96:99], v[184:187], v[160:175]
    ds_read_b64_tr_b16 v[196:197], v236 offset:21504
    ds_read_b64_tr_b16 v[198:199], v236 offset:21760
    s_waitcnt lgkmcnt(4)
    v_mfma_f32_32x32x16_bf16 v[128:143], v[188:191], v[100:103], v[128:143]
    ds_read_b128 v[104:107], v202 offset:16384
    ds_read_b64_tr_b16 v[176:177], v236 offset:14336
    ds_read_b64_tr_b16 v[178:179], v236 offset:14592
    s_waitcnt lgkmcnt(5)
    v_mfma_f32_32x32x16_bf16 v[144:159], v[192:195], v[100:103], v[144:159]
    ds_read_b64_tr_b16 v[180:181], v236 offset:18432
    ds_read_b64_tr_b16 v[182:183], v236 offset:18688
    s_waitcnt lgkmcnt(5)
    v_mfma_f32_32x32x16_bf16 v[160:175], v[100:103], v[196:199], v[160:175]
    ds_read_b64_tr_b16 v[184:185], v236 offset:22528
    ds_read_b64_tr_b16 v[186:187], v236 offset:22784
    s_barrier
    s_waitcnt lgkmcnt(4)
    v_mfma_f32_32x32x16_bf16 v[128:143], v[176:179], v[104:107], v[128:143]
    ds_read_b128 v[108:111], v203 offset:16384
    ds_read_b64_tr_b16 v[188:189], v236 offset:15360
    ds_read_b64_tr_b16 v[190:191], v236 offset:15616
    s_waitcnt lgkmcnt(5)
    v_mfma_f32_32x32x16_bf16 v[144:159], v[180:183], v[104:107], v[144:159]
    ds_read_b64_tr_b16 v[192:193], v236 offset:19456
    ds_read_b64_tr_b16 v[194:195], v236 offset:19712
    s_waitcnt lgkmcnt(5)
    v_mfma_f32_32x32x16_bf16 v[160:175], v[104:107], v[184:187], v[160:175]
    ds_read_b64_tr_b16 v[196:197], v236 offset:23552
    ds_read_b64_tr_b16 v[198:199], v236 offset:23808
    s_waitcnt lgkmcnt(4)
    v_mfma_f32_32x32x16_bf16 v[128:143], v[188:191], v[108:111], v[128:143]
    ds_read_b128 v[112:115], v200 offset:32768
    ds_read_b64_tr_b16 v[176:177], v236 offset:24576
    ds_read_b64_tr_b16 v[178:179], v236 offset:24832
    s_waitcnt lgkmcnt(5)
    v_mfma_f32_32x32x16_bf16 v[144:159], v[192:195], v[108:111], v[144:159]
    ds_read_b64_tr_b16 v[180:181], v236 offset:28672
    ds_read_b64_tr_b16 v[182:183], v236 offset:28928
    s_waitcnt lgkmcnt(5)
    v_mfma_f32_32x32x16_bf16 v[160:175], v[108:111], v[196:199], v[160:175]
    ds_read_b64_tr_b16 v[184:185], v236 offset:32768
    ds_read_b64_tr_b16 v[186:187], v236 offset:33024
    s_waitcnt lgkmcnt(4)
    v_mfma_f32_32x32x16_bf16 v[128:143], v[176:179], v[112:115], v[128:143]
    ds_read_b128 v[116:119], v201 offset:32768
    ds_read_b64_tr_b16 v[188:189], v236 offset:25600
    ds_read_b64_tr_b16 v[190:191], v236 offset:25856
    s_waitcnt lgkmcnt(5)
    v_mfma_f32_32x32x16_bf16 v[144:159], v[180:183], v[112:115], v[144:159]
    ds_read_b64_tr_b16 v[192:193], v236 offset:29696
    ds_read_b64_tr_b16 v[194:195], v236 offset:29952
    s_waitcnt lgkmcnt(5)
    v_mfma_f32_32x32x16_bf16 v[160:175], v[112:115], v[184:187], v[160:175]
    ds_read_b64_tr_b16 v[196:197], v236 offset:33792
    ds_read_b64_tr_b16 v[198:199], v236 offset:34048
    s_waitcnt lgkmcnt(4)
    v_mfma_f32_32x32x16_bf16 v[128:143], v[188:191], v[116:119], v[128:143]
    ds_read_b128 v[120:123], v202 offset:32768
    ds_read_b64_tr_b16 v[176:177], v236 offset:26624
    ds_read_b64_tr_b16 v[178:179], v236 offset:26880
    s_waitcnt lgkmcnt(5)
    v_mfma_f32_32x32x16_bf16 v[144:159], v[192:195], v[116:119], v[144:159]
    ds_read_b64_tr_b16 v[180:181], v236 offset:30720
    ds_read_b64_tr_b16 v[182:183], v236 offset:30976
    s_waitcnt lgkmcnt(5)
    v_mfma_f32_32x32x16_bf16 v[160:175], v[116:119], v[196:199], v[160:175]
    ds_read_b64_tr_b16 v[184:185], v236 offset:34816
    ds_read_b64_tr_b16 v[186:187], v236 offset:35072
    s_barrier
    s_waitcnt lgkmcnt(4)
    v_mfma_f32_32x32x16_bf16 v[128:143], v[176:179], v[120:123], v[128:143]
    ds_read_b128 v[124:127], v203 offset:32768
    ds_read_b64_tr_b16 v[188:189], v236 offset:27648
    ds_read_b64_tr_b16 v[190:191], v236 offset:27904
    s_waitcnt lgkmcnt(5)
    v_mfma_f32_32x32x16_bf16 v[144:159], v[180:183], v[120:123], v[144:159]
    ds_read_b64_tr_b16 v[192:193], v236 offset:31744
    ds_read_b64_tr_b16 v[194:195], v236 offset:32000
    s_waitcnt lgkmcnt(5)
    v_mfma_f32_32x32x16_bf16 v[160:175], v[120:123], v[184:187], v[160:175]
    ds_read_b64_tr_b16 v[196:197], v236 offset:35840
    ds_read_b64_tr_b16 v[198:199], v236 offset:36096
    s_waitcnt lgkmcnt(4)
    v_mfma_f32_32x32x16_bf16 v[128:143], v[188:191], v[124:127], v[128:143]
    ds_read_b64_tr_b16 v[176:177], v236 offset:36864
    ds_read_b64_tr_b16 v[178:179], v236 offset:37120
    s_waitcnt lgkmcnt(4)
    v_mfma_f32_32x32x16_bf16 v[144:159], v[192:195], v[124:127], v[144:159]
    ds_read_b64_tr_b16 v[180:181], v236 offset:40960
    ds_read_b64_tr_b16 v[182:183], v236 offset:41216
    s_waitcnt lgkmcnt(4)
    v_mfma_f32_32x32x16_bf16 v[160:175], v[124:127], v[196:199], v[160:175]
    ds_read_b64_tr_b16 v[184:185], v236 offset:45056
    ds_read_b64_tr_b16 v[186:187], v236 offset:45312
    s_nop 3
    v_mul_f32 v128, s56, v128
    v_mul_f32 v129, s56, v129
    v_mul_f32 v130, s56, v130
    v_mul_f32 v131, s56, v131
    v_mul_f32 v132, s56, v132
    v_mul_f32 v133, s56, v133
    v_mul_f32 v134, s56, v134
    v_mul_f32 v135, s56, v135
    v_mul_f32 v136, s56, v136
    v_mul_f32 v137, s56, v137
    v_mul_f32 v138, s56, v138
    v_mul_f32 v139, s56, v139
    v_mul_f32 v140, s56, v140
    v_mul_f32 v141, s56, v141
    v_mul_f32 v142, s56, v142
    v_mul_f32 v143, s56, v143
    v_cvt_pk_bf16_f32 v228, v128, v129
    v_cvt_pk_bf16_f32 v229, v130, v131
    v_cvt_pk_bf16_f32 v230, v132, v133
    v_cvt_pk_bf16_f32 v231, v134, v135
    v_cvt_pk_bf16_f32 v232, v136, v137
    v_cvt_pk_bf16_f32 v233, v138, v139
    v_cvt_pk_bf16_f32 v234, v140, v141
    v_cvt_pk_bf16_f32 v235, v142, v143
    s_waitcnt lgkmcnt(4)
    v_mfma_f32_32x32x16_bf16 v[128:143], v[176:179], v[0:3], 0
    ds_read_b64_tr_b16 v[188:189], v236 offset:37888
    ds_read_b64_tr_b16 v[190:191], v236 offset:38144
    v_cvt_pk_bf16_f32 v212, v144, v145
    v_cvt_pk_bf16_f32 v213, v146, v147
    v_cvt_pk_bf16_f32 v214, v148, v149
    v_cvt_pk_bf16_f32 v215, v150, v151
    v_cvt_pk_bf16_f32 v216, v152, v153
    v_cvt_pk_bf16_f32 v217, v154, v155
    v_cvt_pk_bf16_f32 v218, v156, v157
    v_cvt_pk_bf16_f32 v219, v158, v159
    s_waitcnt lgkmcnt(4)
    v_mfma_f32_32x32x16_bf16 v[144:159], v[180:183], v[0:3], 0
    ds_read_b64_tr_b16 v[192:193], v236 offset:41984
    ds_read_b64_tr_b16 v[194:195], v236 offset:42240
    v_cvt_pk_bf16_f32 v220, v160, v161
    v_cvt_pk_bf16_f32 v221, v162, v163
    v_cvt_pk_bf16_f32 v222, v164, v165
    v_cvt_pk_bf16_f32 v223, v166, v167
    v_cvt_pk_bf16_f32 v224, v168, v169
    v_cvt_pk_bf16_f32 v225, v170, v171
    v_cvt_pk_bf16_f32 v226, v172, v173
    v_cvt_pk_bf16_f32 v227, v174, v175
    s_waitcnt lgkmcnt(4)
    v_mfma_f32_32x32x16_bf16 v[160:175], v[184:187], v[0:3], 0
    ds_read_b64_tr_b16 v[196:197], v236 offset:46080
    ds_read_b64_tr_b16 v[198:199], v236 offset:46336
    s_add_u32 s49, s55, 0x200000
    buffer_store_dwordx4 v[212:215], v251, s[28:31], s49 offen sc1
    s_waitcnt lgkmcnt(4)
    v_mfma_f32_32x32x16_bf16 v[128:143], v[188:191], v[4:7], v[128:143]
    ds_read_b64_tr_b16 v[176:177], v236 offset:38912
    ds_read_b64_tr_b16 v[178:179], v236 offset:39168
    s_waitcnt lgkmcnt(4)
    v_mfma_f32_32x32x16_bf16 v[144:159], v[192:195], v[4:7], v[144:159]
    ds_read_b64_tr_b16 v[180:181], v236 offset:43008
    ds_read_b64_tr_b16 v[182:183], v236 offset:43264
    s_waitcnt lgkmcnt(4)
    v_mfma_f32_32x32x16_bf16 v[160:175], v[196:199], v[4:7], v[160:175]
    ds_read_b64_tr_b16 v[184:185], v236 offset:47104
    ds_read_b64_tr_b16 v[186:187], v236 offset:47360
    s_add_u32 s49, s55, 0x210000
    buffer_store_dwordx4 v[216:219], v251, s[28:31], s49 offen sc1
    s_barrier
    s_waitcnt lgkmcnt(4)
    v_mfma_f32_32x32x16_bf16 v[128:143], v[176:179], v[8:11], v[128:143]
    ds_read_b64_tr_b16 v[188:189], v236 offset:39936
    ds_read_b64_tr_b16 v[190:191], v236 offset:40192
    s_waitcnt lgkmcnt(4)
    v_mfma_f32_32x32x16_bf16 v[144:159], v[180:183], v[8:11], v[144:159]
    ds_read_b64_tr_b16 v[192:193], v236 offset:44032
    ds_read_b64_tr_b16 v[194:195], v236 offset:44288
    s_waitcnt lgkmcnt(4)
    v_mfma_f32_32x32x16_bf16 v[160:175], v[184:187], v[8:11], v[160:175]
    ds_read_b64_tr_b16 v[196:197], v236 offset:48128
    ds_read_b64_tr_b16 v[198:199], v236 offset:48384
    s_add_u32 s49, s55, 0x400000
    buffer_store_dwordx4 v[220:223], v237, s[28:31], s49 offen sc1
    s_waitcnt lgkmcnt(4)
    v_mfma_f32_32x32x16_bf16 v[128:143], v[188:191], v[12:15], v[128:143]
    ds_read_b64_tr_b16 v[176:177], v236 offset:49152
    ds_read_b64_tr_b16 v[178:179], v236 offset:49408
    s_waitcnt lgkmcnt(4)
    v_mfma_f32_32x32x16_bf16 v[144:159], v[192:195], v[12:15], v[144:159]
    ds_read_b64_tr_b16 v[180:181], v236 offset:53248
    ds_read_b64_tr_b16 v[182:183], v236 offset:53504
    s_waitcnt lgkmcnt(4)
    v_mfma_f32_32x32x16_bf16 v[160:175], v[196:199], v[12:15], v[160:175]
    ds_read_b64_tr_b16 v[184:185], v236 offset:57344
    ds_read_b64_tr_b16 v[186:187], v236 offset:57600
    s_add_u32 s49, s55, 0x400200
    buffer_store_dwordx4 v[224:227], v237, s[28:31], s49 offen sc1
    s_waitcnt lgkmcnt(4)
    v_mfma_f32_32x32x16_bf16 v[128:143], v[176:179], v[16:19], v[128:143]
    ds_read_b64_tr_b16 v[188:189], v236 offset:50176
    ds_read_b64_tr_b16 v[190:191], v236 offset:50432
    s_waitcnt lgkmcnt(4)
    v_mfma_f32_32x32x16_bf16 v[144:159], v[180:183], v[16:19], v[144:159]
    ds_read_b64_tr_b16 v[192:193], v236 offset:54272
    ds_read_b64_tr_b16 v[194:195], v236 offset:54528
    s_waitcnt lgkmcnt(4)
    v_mfma_f32_32x32x16_bf16 v[160:175], v[184:187], v[16:19], v[160:175]
    ds_read_b64_tr_b16 v[196:197], v236 offset:58368
    ds_read_b64_tr_b16 v[198:199], v236 offset:58624
    s_add_u32 s49, s55, 0x0
    buffer_store_dwordx4 v[228:231], v251, s[28:31], s49 offen sc1
    s_waitcnt lgkmcnt(4)
    v_mfma_f32_32x32x16_bf16 v[128:143], v[188:191], v[20:23], v[128:143]
    ds_read_b64_tr_b16 v[176:177], v236 offset:51200
    ds_read_b64_tr_b16 v[178:179], v236 offset:51456
    s_waitcnt lgkmcnt(4)
    v_mfma_f32_32x32x16_bf16 v[144:159], v[192:195], v[20:23], v[144:159]
    ds_read_b64_tr_b16 v[180:181], v236 offset:55296
    ds_read_b64_tr_b16 v[182:183], v236 offset:55552
    s_waitcnt lgkmcnt(4)
    v_mfma_f32_32x32x16_bf16 v[160:175], v[196:199], v[20:23], v[160:175]
    ds_read_b64_tr_b16 v[184:185], v236 offset:59392
    ds_read_b64_tr_b16 v[186:187], v236 offset:59648
    s_add_u32 s49, s55, 0x10000
    buffer_store_dwordx4 v[232:235], v251, s[28:31], s49 offen sc1
    s_barrier
    s_waitcnt lgkmcnt(4)
    v_mfma_f32_32x32x16_bf16 v[128:143], v[176:179], v[24:27], v[128:143]
    ds_read_b64_tr_b16 v[188:189], v236 offset:52224
    ds_read_b64_tr_b16 v[190:191], v236 offset:52480
    s_waitcnt lgkmcnt(4)
    v_mfma_f32_32x32x16_bf16 v[144:159], v[180:183], v[24:27], v[144:159]
    ds_read_b64_tr_b16 v[192:193], v236 offset:56320
    ds_read_b64_tr_b16 v[194:195], v236 offset:56576
    s_waitcnt lgkmcnt(4)
    v_mfma_f32_32x32x16_bf16 v[160:175], v[184:187], v[24:27], v[160:175]
    ds_read_b64_tr_b16 v[196:197], v236 offset:60416
    ds_read_b64_tr_b16 v[198:199], v236 offset:60672
    s_waitcnt lgkmcnt(4)
    v_mfma_f32_32x32x16_bf16 v[128:143], v[188:191], v[28:31], v[128:143]
    ds_read_b64_tr_b16 v[176:177], v236 offset:0
    ds_read_b64_tr_b16 v[178:179], v236 offset:256
    s_waitcnt lgkmcnt(4)
    v_mfma_f32_32x32x16_bf16 v[144:159], v[192:195], v[28:31], v[144:159]
    ds_read_b64_tr_b16 v[180:181], v236 offset:4096
    ds_read_b64_tr_b16 v[182:183], v236 offset:4352
    s_waitcnt lgkmcnt(4)
    v_mfma_f32_32x32x16_bf16 v[160:175], v[196:199], v[28:31], v[160:175]
    ds_read_b64_tr_b16 v[184:185], v236 offset:8192
    ds_read_b64_tr_b16 v[186:187], v236 offset:8448
    s_waitcnt lgkmcnt(4)
    v_mfma_f32_32x32x16_bf16 v[128:143], v[176:179], v[32:35], v[128:143]
    ds_read_b64_tr_b16 v[188:189], v236 offset:1024
    ds_read_b64_tr_b16 v[190:191], v236 offset:1280
    s_waitcnt lgkmcnt(4)
    v_mfma_f32_32x32x16_bf16 v[144:159], v[180:183], v[32:35], v[144:159]
    ds_read_b64_tr_b16 v[192:193], v236 offset:5120
    ds_read_b64_tr_b16 v[194:195], v236 offset:5376
    s_waitcnt lgkmcnt(4)
    v_mfma_f32_32x32x16_bf16 v[160:175], v[184:187], v[32:35], v[160:175]
    ds_read_b64_tr_b16 v[196:197], v236 offset:9216
    ds_read_b64_tr_b16 v[198:199], v236 offset:9472
    s_waitcnt lgkmcnt(4)
    v_mfma_f32_32x32x16_bf16 v[128:143], v[188:191], v[36:39], v[128:143]
    ds_read_b64_tr_b16 v[176:177], v236 offset:2048
    ds_read_b64_tr_b16 v[178:179], v236 offset:2304
    s_waitcnt lgkmcnt(4)
    v_mfma_f32_32x32x16_bf16 v[144:159], v[192:195], v[36:39], v[144:159]
    ds_read_b64_tr_b16 v[180:181], v236 offset:6144
    ds_read_b64_tr_b16 v[182:183], v236 offset:6400
    s_waitcnt lgkmcnt(4)
    v_mfma_f32_32x32x16_bf16 v[160:175], v[196:199], v[36:39], v[160:175]
    ds_read_b64_tr_b16 v[184:185], v236 offset:10240
    ds_read_b64_tr_b16 v[186:187], v236 offset:10496
    s_barrier
    s_waitcnt lgkmcnt(4)
    v_mfma_f32_32x32x16_bf16 v[128:143], v[176:179], v[40:43], v[128:143]
    ds_read_b64_tr_b16 v[188:189], v236 offset:3072
    ds_read_b64_tr_b16 v[190:191], v236 offset:3328
    s_waitcnt lgkmcnt(4)
    v_mfma_f32_32x32x16_bf16 v[144:159], v[180:183], v[40:43], v[144:159]
    ds_read_b64_tr_b16 v[192:193], v236 offset:7168
    ds_read_b64_tr_b16 v[194:195], v236 offset:7424
    s_waitcnt lgkmcnt(4)
    v_mfma_f32_32x32x16_bf16 v[160:175], v[184:187], v[40:43], v[160:175]
    ds_read_b64_tr_b16 v[196:197], v236 offset:11264
    ds_read_b64_tr_b16 v[198:199], v236 offset:11520
    s_waitcnt lgkmcnt(4)
    v_mfma_f32_32x32x16_bf16 v[128:143], v[188:191], v[44:47], v[128:143]
    ds_read_b64_tr_b16 v[176:177], v236 offset:12288
    ds_read_b64_tr_b16 v[178:179], v236 offset:12544
    s_waitcnt lgkmcnt(4)
    v_mfma_f32_32x32x16_bf16 v[144:159], v[192:195], v[44:47], v[144:159]
    ds_read_b64_tr_b16 v[180:181], v236 offset:16384
    ds_read_b64_tr_b16 v[182:183], v236 offset:16640
    s_waitcnt lgkmcnt(4)
    v_mfma_f32_32x32x16_bf16 v[160:175], v[196:199], v[44:47], v[160:175]
    ds_read_b64_tr_b16 v[184:185], v236 offset:20480
    ds_read_b64_tr_b16 v[186:187], v236 offset:20736
    s_lshl_b32 s49, s3, 6
    s_lshl_b32 s50, s41, 2
    s_add_u32 s49, s49, s50
    s_add_u32 s49, s49, s40
    s_lshl_b32 s49, s49, 3
    s_add_u32 s49, s49, 0xf01000
    s_waitcnt vmcnt(0)
    s_mov_b64 exec, 1
    buffer_store_dwordx2 v[248:249], v247, s[28:31], s49 offen sc1
    s_mov_b64 exec, -1
    s_waitcnt lgkmcnt(4)
    v_mfma_f32_32x32x16_bf16 v[128:143], v[176:179], v[48:51], v[128:143]
    ds_read_b64_tr_b16 v[188:189], v236 offset:13312
    ds_read_b64_tr_b16 v[190:191], v236 offset:13568
    s_waitcnt lgkmcnt(4)
    v_mfma_f32_32x32x16_bf16 v[144:159], v[180:183], v[48:51], v[144:159]
    ds_read_b64_tr_b16 v[192:193], v236 offset:17408
    ds_read_b64_tr_b16 v[194:195], v236 offset:17664
    s_waitcnt lgkmcnt(4)
    v_mfma_f32_32x32x16_bf16 v[160:175], v[184:187], v[48:51], v[160:175]
    ds_read_b64_tr_b16 v[196:197], v236 offset:21504
    ds_read_b64_tr_b16 v[198:199], v236 offset:21760
    s_waitcnt lgkmcnt(4)
    v_mfma_f32_32x32x16_bf16 v[128:143], v[188:191], v[52:55], v[128:143]
    ds_read_b64_tr_b16 v[176:177], v236 offset:14336
    ds_read_b64_tr_b16 v[178:179], v236 offset:14592
    s_waitcnt lgkmcnt(4)
    v_mfma_f32_32x32x16_bf16 v[144:159], v[192:195], v[52:55], v[144:159]
    ds_read_b64_tr_b16 v[180:181], v236 offset:18432
    ds_read_b64_tr_b16 v[182:183], v236 offset:18688
    s_waitcnt lgkmcnt(4)
    v_mfma_f32_32x32x16_bf16 v[160:175], v[196:199], v[52:55], v[160:175]
    ds_read_b64_tr_b16 v[184:185], v236 offset:22528
    ds_read_b64_tr_b16 v[186:187], v236 offset:22784
    s_barrier
    s_waitcnt lgkmcnt(4)
    v_mfma_f32_32x32x16_bf16 v[128:143], v[176:179], v[56:59], v[128:143]
    ds_read_b64_tr_b16 v[188:189], v236 offset:15360
    ds_read_b64_tr_b16 v[190:191], v236 offset:15616
    s_waitcnt lgkmcnt(4)
    v_mfma_f32_32x32x16_bf16 v[144:159], v[180:183], v[56:59], v[144:159]
    ds_read_b64_tr_b16 v[192:193], v236 offset:19456
    ds_read_b64_tr_b16 v[194:195], v236 offset:19712
    s_waitcnt lgkmcnt(4)
    v_mfma_f32_32x32x16_bf16 v[160:175], v[184:187], v[56:59], v[160:175]
    ds_read_b64_tr_b16 v[196:197], v236 offset:23552
    ds_read_b64_tr_b16 v[198:199], v236 offset:23808
    s_waitcnt lgkmcnt(4)
    v_mfma_f32_32x32x16_bf16 v[128:143], v[188:191], v[60:63], v[128:143]
    ds_read_b64_tr_b16 v[176:177], v236 offset:24576
    ds_read_b64_tr_b16 v[178:179], v236 offset:24832
    s_waitcnt lgkmcnt(4)
    v_mfma_f32_32x32x16_bf16 v[144:159], v[192:195], v[60:63], v[144:159]
    ds_read_b64_tr_b16 v[180:181], v236 offset:28672
    ds_read_b64_tr_b16 v[182:183], v236 offset:28928
    s_waitcnt lgkmcnt(4)
    v_mfma_f32_32x32x16_bf16 v[160:175], v[196:199], v[60:63], v[160:175]
    ds_read_b64_tr_b16 v[184:185], v236 offset:32768
    ds_read_b64_tr_b16 v[186:187], v236 offset:33024
    s_waitcnt lgkmcnt(4)
    v_mfma_f32_32x32x16_bf16 v[128:143], v[176:179], v[64:67], v[128:143]
    ds_read_b64_tr_b16 v[188:189], v236 offset:25600
    ds_read_b64_tr_b16 v[190:191], v236 offset:25856
    s_waitcnt lgkmcnt(4)
    v_mfma_f32_32x32x16_bf16 v[144:159], v[180:183], v[64:67], v[144:159]
    ds_read_b64_tr_b16 v[192:193], v236 offset:29696
    ds_read_b64_tr_b16 v[194:195], v236 offset:29952
    s_waitcnt lgkmcnt(4)
    v_mfma_f32_32x32x16_bf16 v[160:175], v[184:187], v[64:67], v[160:175]
    ds_read_b64_tr_b16 v[196:197], v236 offset:33792
    ds_read_b64_tr_b16 v[198:199], v236 offset:34048
    s_waitcnt lgkmcnt(4)
    v_mfma_f32_32x32x16_bf16 v[128:143], v[188:191], v[68:71], v[128:143]
    ds_read_b64_tr_b16 v[176:177], v236 offset:26624
    ds_read_b64_tr_b16 v[178:179], v236 offset:26880
    s_waitcnt lgkmcnt(4)
    v_mfma_f32_32x32x16_bf16 v[144:159], v[192:195], v[68:71], v[144:159]
    ds_read_b64_tr_b16 v[180:181], v236 offset:30720
    ds_read_b64_tr_b16 v[182:183], v236 offset:30976
    s_waitcnt lgkmcnt(4)
    v_mfma_f32_32x32x16_bf16 v[160:175], v[196:199], v[68:71], v[160:175]
    ds_read_b64_tr_b16 v[184:185], v236 offset:34816
    ds_read_b64_tr_b16 v[186:187], v236 offset:35072
    s_barrier
    s_waitcnt lgkmcnt(4)
    v_mfma_f32_32x32x16_bf16 v[128:143], v[176:179], v[72:75], v[128:143]
    ds_read_b64_tr_b16 v[188:189], v236 offset:27648
    ds_read_b64_tr_b16 v[190:191], v236 offset:27904
    s_waitcnt lgkmcnt(4)
    v_mfma_f32_32x32x16_bf16 v[144:159], v[180:183], v[72:75], v[144:159]
    ds_read_b64_tr_b16 v[192:193], v236 offset:31744
    ds_read_b64_tr_b16 v[194:195], v236 offset:32000
    s_waitcnt lgkmcnt(4)
    v_mfma_f32_32x32x16_bf16 v[160:175], v[184:187], v[72:75], v[160:175]
    ds_read_b64_tr_b16 v[196:197], v236 offset:35840
    ds_read_b64_tr_b16 v[198:199], v236 offset:36096
    s_waitcnt lgkmcnt(4)
    v_mfma_f32_32x32x16_bf16 v[128:143], v[188:191], v[76:79], v[128:143]
    ds_read_b64_tr_b16 v[176:177], v236 offset:36864
    ds_read_b64_tr_b16 v[178:179], v236 offset:37120
    s_waitcnt lgkmcnt(4)
    v_mfma_f32_32x32x16_bf16 v[144:159], v[192:195], v[76:79], v[144:159]
    ds_read_b64_tr_b16 v[180:181], v236 offset:40960
    ds_read_b64_tr_b16 v[182:183], v236 offset:41216
    s_waitcnt lgkmcnt(4)
    v_mfma_f32_32x32x16_bf16 v[160:175], v[196:199], v[76:79], v[160:175]
    ds_read_b64_tr_b16 v[184:185], v236 offset:45056
    ds_read_b64_tr_b16 v[186:187], v236 offset:45312
    s_waitcnt lgkmcnt(4)
    v_mfma_f32_32x32x16_bf16 v[128:143], v[176:179], v[80:83], v[128:143]
    ds_read_b64_tr_b16 v[188:189], v236 offset:37888
    ds_read_b64_tr_b16 v[190:191], v236 offset:38144
    s_waitcnt lgkmcnt(4)
    v_mfma_f32_32x32x16_bf16 v[144:159], v[180:183], v[80:83], v[144:159]
    ds_read_b64_tr_b16 v[192:193], v236 offset:41984
    ds_read_b64_tr_b16 v[194:195], v236 offset:42240
    s_waitcnt lgkmcnt(4)
    v_mfma_f32_32x32x16_bf16 v[160:175], v[184:187], v[80:83], v[160:175]
    ds_read_b64_tr_b16 v[196:197], v236 offset:46080
    ds_read_b64_tr_b16 v[198:199], v236 offset:46336
    s_waitcnt lgkmcnt(4)
    v_mfma_f32_32x32x16_bf16 v[128:143], v[188:191], v[84:87], v[128:143]
    ds_read_b64_tr_b16 v[176:177], v236 offset:38912
    ds_read_b64_tr_b16 v[178:179], v236 offset:39168
    s_waitcnt lgkmcnt(4)
    v_mfma_f32_32x32x16_bf16 v[144:159], v[192:195], v[84:87], v[144:159]
    ds_read_b64_tr_b16 v[180:181], v236 offset:43008
    ds_read_b64_tr_b16 v[182:183], v236 offset:43264
    s_waitcnt lgkmcnt(4)
    v_mfma_f32_32x32x16_bf16 v[160:175], v[196:199], v[84:87], v[160:175]
    ds_read_b64_tr_b16 v[184:185], v236 offset:47104
    ds_read_b64_tr_b16 v[186:187], v236 offset:47360
    s_barrier
    s_waitcnt lgkmcnt(4)
    v_mfma_f32_32x32x16_bf16 v[128:143], v[176:179], v[88:91], v[128:143]
    ds_read_b64_tr_b16 v[188:189], v236 offset:39936
    ds_read_b64_tr_b16 v[190:191], v236 offset:40192
    s_waitcnt lgkmcnt(4)
    v_mfma_f32_32x32x16_bf16 v[144:159], v[180:183], v[88:91], v[144:159]
    ds_read_b64_tr_b16 v[192:193], v236 offset:44032
    ds_read_b64_tr_b16 v[194:195], v236 offset:44288
    s_waitcnt lgkmcnt(4)
    v_mfma_f32_32x32x16_bf16 v[160:175], v[184:187], v[88:91], v[160:175]
    ds_read_b64_tr_b16 v[196:197], v236 offset:48128
    ds_read_b64_tr_b16 v[198:199], v236 offset:48384
    s_waitcnt lgkmcnt(4)
    v_mfma_f32_32x32x16_bf16 v[128:143], v[188:191], v[92:95], v[128:143]
    ds_read_b64_tr_b16 v[176:177], v236 offset:49152
    ds_read_b64_tr_b16 v[178:179], v236 offset:49408
    s_waitcnt lgkmcnt(4)
    v_mfma_f32_32x32x16_bf16 v[144:159], v[192:195], v[92:95], v[144:159]
    ds_read_b64_tr_b16 v[180:181], v236 offset:53248
    ds_read_b64_tr_b16 v[182:183], v236 offset:53504
    s_waitcnt lgkmcnt(4)
    v_mfma_f32_32x32x16_bf16 v[160:175], v[196:199], v[92:95], v[160:175]
    ds_read_b64_tr_b16 v[184:185], v236 offset:57344
    ds_read_b64_tr_b16 v[186:187], v236 offset:57600
    s_waitcnt lgkmcnt(4)
    v_mfma_f32_32x32x16_bf16 v[128:143], v[176:179], v[96:99], v[128:143]
    ds_read_b64_tr_b16 v[188:189], v236 offset:50176
    ds_read_b64_tr_b16 v[190:191], v236 offset:50432
    s_waitcnt lgkmcnt(4)
    v_mfma_f32_32x32x16_bf16 v[144:159], v[180:183], v[96:99], v[144:159]
    ds_read_b64_tr_b16 v[192:193], v236 offset:54272
    ds_read_b64_tr_b16 v[194:195], v236 offset:54528
    s_waitcnt lgkmcnt(4)
    v_mfma_f32_32x32x16_bf16 v[160:175], v[184:187], v[96:99], v[160:175]
    ds_read_b64_tr_b16 v[196:197], v236 offset:58368
    ds_read_b64_tr_b16 v[198:199], v236 offset:58624
    s_waitcnt lgkmcnt(4)
    v_mfma_f32_32x32x16_bf16 v[128:143], v[188:191], v[100:103], v[128:143]
    ds_read_b64_tr_b16 v[176:177], v236 offset:51200
    ds_read_b64_tr_b16 v[178:179], v236 offset:51456
    s_waitcnt lgkmcnt(4)
    v_mfma_f32_32x32x16_bf16 v[144:159], v[192:195], v[100:103], v[144:159]
    ds_read_b64_tr_b16 v[180:181], v236 offset:55296
    ds_read_b64_tr_b16 v[182:183], v236 offset:55552
    s_waitcnt lgkmcnt(4)
    v_mfma_f32_32x32x16_bf16 v[160:175], v[196:199], v[100:103], v[160:175]
    ds_read_b64_tr_b16 v[184:185], v236 offset:59392
    ds_read_b64_tr_b16 v[186:187], v236 offset:59648
    s_barrier
    s_waitcnt lgkmcnt(4)
    v_mfma_f32_32x32x16_bf16 v[128:143], v[176:179], v[104:107], v[128:143]
    ds_read_b64_tr_b16 v[188:189], v236 offset:52224
    ds_read_b64_tr_b16 v[190:191], v236 offset:52480
    s_waitcnt lgkmcnt(4)
    v_mfma_f32_32x32x16_bf16 v[144:159], v[180:183], v[104:107], v[144:159]
    ds_read_b64_tr_b16 v[192:193], v236 offset:56320
    ds_read_b64_tr_b16 v[194:195], v236 offset:56576
    s_waitcnt lgkmcnt(4)
    v_mfma_f32_32x32x16_bf16 v[160:175], v[184:187], v[104:107], v[160:175]
    ds_read_b64_tr_b16 v[196:197], v236 offset:60416
    ds_read_b64_tr_b16 v[198:199], v236 offset:60672
    s_waitcnt lgkmcnt(4)
    v_mfma_f32_32x32x16_bf16 v[128:143], v[188:191], v[108:111], v[128:143]
    ds_read_b64_tr_b16 v[176:177], v236 offset:0
    ds_read_b64_tr_b16 v[178:179], v236 offset:256
    s_waitcnt lgkmcnt(4)
    v_mfma_f32_32x32x16_bf16 v[144:159], v[192:195], v[108:111], v[144:159]
    ds_read_b64_tr_b16 v[180:181], v236 offset:4096
    ds_read_b64_tr_b16 v[182:183], v236 offset:4352
    s_waitcnt lgkmcnt(4)
    v_mfma_f32_32x32x16_bf16 v[160:175], v[196:199], v[108:111], v[160:175]
    ds_read_b64_tr_b16 v[184:185], v236 offset:8192
    ds_read_b64_tr_b16 v[186:187], v236 offset:8448
    s_waitcnt lgkmcnt(4)
    v_mfma_f32_32x32x16_bf16 v[128:143], v[176:179], v[112:115], v[128:143]
    ds_read_b64_tr_b16 v[188:189], v236 offset:1024
    ds_read_b64_tr_b16 v[190:191], v236 offset:1280
    s_waitcnt lgkmcnt(4)
    v_mfma_f32_32x32x16_bf16 v[144:159], v[180:183], v[112:115], v[144:159]
    ds_read_b64_tr_b16 v[192:193], v236 offset:5120
    ds_read_b64_tr_b16 v[194:195], v236 offset:5376
    s_waitcnt lgkmcnt(4)
    v_mfma_f32_32x32x16_bf16 v[160:175], v[184:187], v[112:115], v[160:175]
    ds_read_b64_tr_b16 v[196:197], v236 offset:9216
    ds_read_b64_tr_b16 v[198:199], v236 offset:9472
    s_waitcnt lgkmcnt(4)
    v_mfma_f32_32x32x16_bf16 v[128:143], v[188:191], v[116:119], v[128:143]
    ds_read_b64_tr_b16 v[176:177], v236 offset:2048
    ds_read_b64_tr_b16 v[178:179], v236 offset:2304
    s_waitcnt lgkmcnt(4)
    v_mfma_f32_32x32x16_bf16 v[144:159], v[192:195], v[116:119], v[144:159]
    ds_read_b64_tr_b16 v[180:181], v236 offset:6144
    ds_read_b64_tr_b16 v[182:183], v236 offset:6400
    s_waitcnt lgkmcnt(4)
    v_mfma_f32_32x32x16_bf16 v[160:175], v[196:199], v[116:119], v[160:175]
    ds_read_b64_tr_b16 v[184:185], v236 offset:10240
    ds_read_b64_tr_b16 v[186:187], v236 offset:10496
    s_waitcnt lgkmcnt(4)
    v_mfma_f32_32x32x16_bf16 v[128:143], v[176:179], v[120:123], v[128:143]
    ds_read_b64_tr_b16 v[188:189], v236 offset:3072
    ds_read_b64_tr_b16 v[190:191], v236 offset:3328
    s_waitcnt lgkmcnt(4)
    v_mfma_f32_32x32x16_bf16 v[144:159], v[180:183], v[120:123], v[144:159]
    ds_read_b64_tr_b16 v[192:193], v236 offset:7168
    ds_read_b64_tr_b16 v[194:195], v236 offset:7424
    s_waitcnt lgkmcnt(4)
    v_mfma_f32_32x32x16_bf16 v[160:175], v[184:187], v[120:123], v[160:175]
    ds_read_b64_tr_b16 v[196:197], v236 offset:11264
    ds_read_b64_tr_b16 v[198:199], v236 offset:11520
    s_waitcnt lgkmcnt(4)
    v_mfma_f32_32x32x16_bf16 v[128:143], v[188:191], v[124:127], v[128:143]
    s_waitcnt lgkmcnt(2)
    v_mfma_f32_32x32x16_bf16 v[144:159], v[192:195], v[124:127], v[144:159]
    s_waitcnt lgkmcnt(0)
    v_mfma_f32_32x32x16_bf16 v[160:175], v[196:199], v[124:127], v[160:175]
    s_nop 15
    s_mov_b32 s4, 0xbfb8aa3b
    s_mov_b32 s5, s4
    s_mov_b32 s6, 1.0
    s_mov_b32 s7, 1.0
    v_pk_mul_f32 v[0:1], v[128:129], s[4:5]
    v_pk_mul_f32 v[2:3], v[130:131], s[4:5]
    v_pk_mul_f32 v[4:5], v[132:133], s[4:5]
    v_pk_mul_f32 v[6:7], v[134:135], s[4:5]
    v_exp_f32 v0, v0
    v_exp_f32 v1, v1
    v_exp_f32 v2, v2
    v_exp_f32 v3, v3
    v_exp_f32 v4, v4
    v_exp_f32 v5, v5
    v_exp_f32 v6, v6
    v_exp_f32 v7, v7
    v_pk_add_f32 v[0:1], v[0:1], s[6:7]
    v_pk_add_f32 v[2:3], v[2:3], s[6:7]
    v_pk_add_f32 v[4:5], v[4:5], s[6:7]
    v_pk_add_f32 v[6:7], v[6:7], s[6:7]
    v_rcp_f32 v0, v0
    v_rcp_f32 v1, v1
    v_rcp_f32 v2, v2
    v_rcp_f32 v3, v3
    v_rcp_f32 v4, v4
    v_rcp_f32 v5, v5
    v_rcp_f32 v6, v6
    v_rcp_f32 v7, v7
    v_pk_mul_f32 v[128:129], v[128:129], v[0:1]
    v_pk_mul_f32 v[130:131], v[130:131], v[2:3]
    v_pk_mul_f32 v[132:133], v[132:133], v[4:5]
    v_pk_mul_f32 v[134:135], v[134:135], v[6:7]
    v_cvt_pk_bf16_f32 v212, v128, v129
    v_cvt_pk_bf16_f32 v213, v130, v131
    v_cvt_pk_bf16_f32 v214, v132, v133
    v_cvt_pk_bf16_f32 v215, v134, v135
    v_pk_mul_f32 v[0:1], v[136:137], s[4:5]
    v_pk_mul_f32 v[2:3], v[138:139], s[4:5]
    v_pk_mul_f32 v[4:5], v[140:141], s[4:5]
    v_pk_mul_f32 v[6:7], v[142:143], s[4:5]
    v_exp_f32 v0, v0
    v_exp_f32 v1, v1
    v_exp_f32 v2, v2
    v_exp_f32 v3, v3
    v_exp_f32 v4, v4
    v_exp_f32 v5, v5
    v_exp_f32 v6, v6
    v_exp_f32 v7, v7
    v_pk_add_f32 v[0:1], v[0:1], s[6:7]
    v_pk_add_f32 v[2:3], v[2:3], s[6:7]
    v_pk_add_f32 v[4:5], v[4:5], s[6:7]
    v_pk_add_f32 v[6:7], v[6:7], s[6:7]
    v_rcp_f32 v0, v0
    v_rcp_f32 v1, v1
    v_rcp_f32 v2, v2
    v_rcp_f32 v3, v3
    v_rcp_f32 v4, v4
    v_rcp_f32 v5, v5
    v_rcp_f32 v6, v6
    v_rcp_f32 v7, v7
    v_pk_mul_f32 v[136:137], v[136:137], v[0:1]
    v_pk_mul_f32 v[138:139], v[138:139], v[2:3]
    v_pk_mul_f32 v[140:141], v[140:141], v[4:5]
    v_pk_mul_f32 v[142:143], v[142:143], v[6:7]
    v_cvt_pk_bf16_f32 v216, v136, v137
    v_cvt_pk_bf16_f32 v217, v138, v139
    v_cvt_pk_bf16_f32 v218, v140, v141
    v_cvt_pk_bf16_f32 v219, v142, v143
    v_pk_mul_f32 v[0:1], v[144:145], s[4:5]
    v_pk_mul_f32 v[2:3], v[146:147], s[4:5]
    v_pk_mul_f32 v[4:5], v[148:149], s[4:5]
    v_pk_mul_f32 v[6:7], v[150:151], s[4:5]
    v_exp_f32 v0, v0
    v_exp_f32 v1, v1
    v_exp_f32 v2, v2
    v_exp_f32 v3, v3
    v_exp_f32 v4, v4
    v_exp_f32 v5, v5
    v_exp_f32 v6, v6
    v_exp_f32 v7, v7
    v_pk_add_f32 v[0:1], v[0:1], s[6:7]
    v_pk_add_f32 v[2:3], v[2:3], s[6:7]
    v_pk_add_f32 v[4:5], v[4:5], s[6:7]
    v_pk_add_f32 v[6:7], v[6:7], s[6:7]
    v_rcp_f32 v0, v0
    v_rcp_f32 v1, v1
    v_rcp_f32 v2, v2
    v_rcp_f32 v3, v3
    v_rcp_f32 v4, v4
    v_rcp_f32 v5, v5
    v_rcp_f32 v6, v6
    v_rcp_f32 v7, v7
    v_pk_mul_f32 v[144:145], v[144:145], v[0:1]
    v_pk_mul_f32 v[146:147], v[146:147], v[2:3]
    v_pk_mul_f32 v[148:149], v[148:149], v[4:5]
    v_pk_mul_f32 v[150:151], v[150:151], v[6:7]
    v_cvt_pk_bf16_f32 v220, v144, v145
    v_cvt_pk_bf16_f32 v221, v146, v147
    v_cvt_pk_bf16_f32 v222, v148, v149
    v_cvt_pk_bf16_f32 v223, v150, v151
    v_pk_mul_f32 v[0:1], v[152:153], s[4:5]
    v_pk_mul_f32 v[2:3], v[154:155], s[4:5]
    v_pk_mul_f32 v[4:5], v[156:157], s[4:5]
    v_pk_mul_f32 v[6:7], v[158:159], s[4:5]
    v_exp_f32 v0, v0
    v_exp_f32 v1, v1
    v_exp_f32 v2, v2
    v_exp_f32 v3, v3
    v_exp_f32 v4, v4
    v_exp_f32 v5, v5
    v_exp_f32 v6, v6
    v_exp_f32 v7, v7
    v_pk_add_f32 v[0:1], v[0:1], s[6:7]
    v_pk_add_f32 v[2:3], v[2:3], s[6:7]
    v_pk_add_f32 v[4:5], v[4:5], s[6:7]
    v_pk_add_f32 v[6:7], v[6:7], s[6:7]
    v_rcp_f32 v0, v0
    v_rcp_f32 v1, v1
    v_rcp_f32 v2, v2
    v_rcp_f32 v3, v3
    v_rcp_f32 v4, v4
    v_rcp_f32 v5, v5
    v_rcp_f32 v6, v6
    v_rcp_f32 v7, v7
    v_pk_mul_f32 v[152:153], v[152:153], v[0:1]
    v_pk_mul_f32 v[154:155], v[154:155], v[2:3]
    v_pk_mul_f32 v[156:157], v[156:157], v[4:5]
    v_pk_mul_f32 v[158:159], v[158:159], v[6:7]
    v_cvt_pk_bf16_f32 v224, v152, v153
    v_cvt_pk_bf16_f32 v225, v154, v155
    v_cvt_pk_bf16_f32 v226, v156, v157
    v_cvt_pk_bf16_f32 v227, v158, v159
    v_pk_mul_f32 v[0:1], v[160:161], s[4:5]
    v_pk_mul_f32 v[2:3], v[162:163], s[4:5]
    v_pk_mul_f32 v[4:5], v[164:165], s[4:5]
    v_pk_mul_f32 v[6:7], v[166:167], s[4:5]
    v_exp_f32 v0, v0
    v_exp_f32 v1, v1
    v_exp_f32 v2, v2
    v_exp_f32 v3, v3
    v_exp_f32 v4, v4
    v_exp_f32 v5, v5
    v_exp_f32 v6, v6
    v_exp_f32 v7, v7
    v_pk_add_f32 v[0:1], v[0:1], s[6:7]
    v_pk_add_f32 v[2:3], v[2:3], s[6:7]
    v_pk_add_f32 v[4:5], v[4:5], s[6:7]
    v_pk_add_f32 v[6:7], v[6:7], s[6:7]
    v_rcp_f32 v0, v0
    v_rcp_f32 v1, v1
    v_rcp_f32 v2, v2
    v_rcp_f32 v3, v3
    v_rcp_f32 v4, v4
    v_rcp_f32 v5, v5
    v_rcp_f32 v6, v6
    v_rcp_f32 v7, v7
    v_pk_mul_f32 v[160:161], v[160:161], v[0:1]
    v_pk_mul_f32 v[162:163], v[162:163], v[2:3]
    v_pk_mul_f32 v[164:165], v[164:165], v[4:5]
    v_pk_mul_f32 v[166:167], v[166:167], v[6:7]
    v_cvt_pk_bf16_f32 v228, v160, v161
    v_cvt_pk_bf16_f32 v229, v162, v163
    v_cvt_pk_bf16_f32 v230, v164, v165
    v_cvt_pk_bf16_f32 v231, v166, v167
    v_pk_mul_f32 v[0:1], v[168:169], s[4:5]
    v_pk_mul_f32 v[2:3], v[170:171], s[4:5]
    v_pk_mul_f32 v[4:5], v[172:173], s[4:5]
    v_pk_mul_f32 v[6:7], v[174:175], s[4:5]
    v_exp_f32 v0, v0
    v_exp_f32 v1, v1
    v_exp_f32 v2, v2
    v_exp_f32 v3, v3
    v_exp_f32 v4, v4
    v_exp_f32 v5, v5
    v_exp_f32 v6, v6
    v_exp_f32 v7, v7
    v_pk_add_f32 v[0:1], v[0:1], s[6:7]
    v_pk_add_f32 v[2:3], v[2:3], s[6:7]
    v_pk_add_f32 v[4:5], v[4:5], s[6:7]
    v_pk_add_f32 v[6:7], v[6:7], s[6:7]
    v_rcp_f32 v0, v0
    v_rcp_f32 v1, v1
    v_rcp_f32 v2, v2
    v_rcp_f32 v3, v3
    v_rcp_f32 v4, v4
    v_rcp_f32 v5, v5
    v_rcp_f32 v6, v6
    v_rcp_f32 v7, v7
    v_pk_mul_f32 v[168:169], v[168:169], v[0:1]
    v_pk_mul_f32 v[170:171], v[170:171], v[2:3]
    v_pk_mul_f32 v[172:173], v[172:173], v[4:5]
    v_pk_mul_f32 v[174:175], v[174:175], v[6:7]
    v_cvt_pk_bf16_f32 v232, v168, v169
    v_cvt_pk_bf16_f32 v233, v170, v171
    v_cvt_pk_bf16_f32 v234, v172, v173
    v_cvt_pk_bf16_f32 v235, v174, v175
    s_cmp_eq_u32 s42, 14
    s_cbranch_scc0 L5_nz
    v_mov_b32 v220, 0
    v_mov_b32 v221, 0
    v_mov_b32 v222, 0
    v_mov_b32 v223, 0
    v_mov_b32 v224, 0
    v_mov_b32 v225, 0
    v_mov_b32 v226, 0
    v_mov_b32 v227, 0
L5_nz:
L4_join:
    v_mov_b32 v108, v251
    v_and_b32 v1, 15, v250
    v_lshlrev_b32 v1, 4, v1
    v_lshrrev_b32 v2, 5, v250
    v_lshlrev_b32 v2, 8, v2
    v_add_u32 v1, v1, v2
    v_add_u32 v109, 65536, v1
    v_and_b32 v1, 31, v250
    v_mov_b32 v2, 0
    v_mov_b32 v3, 0x3f803f80
    v_cmp_eq_u32 vcc, 16, v1
    s_nop 1
    v_cndmask_b32 v2, v2, v3, vcc
    v_cmp_eq_u32 vcc, 20, v1
    s_nop 1
    v_cndmask_b32 v2, v2, v3, vcc
    v_mov_b32 v76, v2
    v_mov_b32 v77, v2
    v_mov_b32 v78, v2
    v_mov_b32 v79, v2
    v_mov_b32 v80, v2
    v_mov_b32 v81, v2
    v_mov_b32 v82, v2
    v_mov_b32 v83, v2
    v_mov_b32 v84, v2
    v_mov_b32 v85, v2
    v_mov_b32 v86, v2
    v_mov_b32 v87, v2
    v_mov_b32 v88, v2
    v_mov_b32 v89, v2
    v_mov_b32 v90, v2
    v_mov_b32 v91, v2
    v_mov_b32 v92, v2
    v_mov_b32 v93, v2
    v_mov_b32 v94, v2
    v_mov_b32 v95, v2
    v_mov_b32 v96, v2
    v_mov_b32 v97, v2
    v_mov_b32 v98, v2
    v_mov_b32 v99, v2
    v_mov_b32 v100, v2
    v_mov_b32 v101, v2
    v_mov_b32 v102, v2
    v_mov_b32 v103, v2
    v_mov_b32 v104, v2
    v_mov_b32 v105, v2
    v_mov_b32 v106, v2
    v_mov_b32 v107, v2
    v_mov_b32 v40, 0
    v_mov_b32 v41, 0
    v_mov_b32 v42, 0
    v_mov_b32 v43, 0
    v_mov_b32 v44, 0
    v_mov_b32 v45, 0
    v_mov_b32 v46, 0
    v_mov_b32 v47, 0
    v_mov_b32 v48, 0
    v_mov_b32 v49, 0
    v_mov_b32 v50, 0
    v_mov_b32 v51, 0
    v_mov_b32 v52, 0
    v_mov_b32 v53, 0
    v_mov_b32 v54, 0
    v_mov_b32 v55, 0
    v_mov_b32 v36, 0
    v_mov_b32 v37, 0
    v_mov_b32 v38, 0
    v_mov_b32 v39, 0
    s_mov_b32 s60, 0x0000ffff
    s_mov_b32 s61, 0x0000ffff
    s_cmp_lt_u32 s40, 4
    s_cbranch_scc1 L6_nowait
    s_waitcnt vmcnt(0)
L6_nowait:
    s_barrier
    s_lshl_b32 s49, s40, 10
    s_add_u32 s49, s49, 147456
    v_add_u32 v1, s49, v251
    ds_read_b128 v[56:59], v1
    ds_read_b128 v[60:63], v108
    ds_read_b128 v[64:67], v108 offset:1024
    ds_read_b128 v[68:71], v108 offset:2048
    s_mov_b64 exec, s[60:61]
    ds_read_b128 v[76:79], v109
    ds_read_b128 v[92:95], v109 offset:512
    ds_read_b128 v[80:83], v109 offset:1024
    s_mov_b64 exec, -1
    s_cmp_lt_u32 s40, 4
    s_cbranch_scc1 L7_nokv
    s_add_u32 s49, s97, 0x205000
    s_add_u32 m0, s96, 20480
    s_add_u32 s52, s97, 0x405000
    buffer_load_dwordx4 v251, s[28:31], s49 offen sc1 lds
    s_add_u32 m0, s96, 86016
    s_nop 0
    buffer_load_dwordx4 v251, s[28:31], s52 offen sc1 lds
    s_add_u32 s49, s97, 0x206000
    s_add_u32 m0, s96, 24576
    s_add_u32 s52, s97, 0x406000
    buffer_load_dwordx4 v251, s[28:31], s49 offen sc1 lds
    s_add_u32 m0, s96, 90112
    s_nop 0
    buffer_load_dwordx4 v251, s[28:31], s52 offen sc1 lds
    s_add_u32 s49, s97, 0x207000
    s_add_u32 m0, s96, 28672
    s_add_u32 s52, s97, 0x407000
    buffer_load_dwordx4 v251, s[28:31], s49 offen sc1 lds
    s_add_u32 m0, s96, 94208
    s_nop 0
    buffer_load_dwordx4 v251, s[28:31], s52 offen sc1 lds
    s_add_u32 s49, s97, 0x208000
    s_add_u32 m0, s96, 32768
    s_add_u32 s52, s97, 0x408000
    buffer_load_dwordx4 v251, s[28:31], s49 offen sc1 lds
    s_add_u32 m0, s96, 98304
    s_nop 0
    buffer_load_dwordx4 v251, s[28:31], s52 offen sc1 lds
    s_add_u32 s49, s97, 0x209000
    s_add_u32 m0, s96, 36864
    s_add_u32 s52, s97, 0x409000
    buffer_load_dwordx4 v251, s[28:31], s49 offen sc1 lds
    s_add_u32 m0, s96, 102400
    s_nop 0
    buffer_load_dwordx4 v251, s[28:31], s52 offen sc1 lds
    s_add_u32 s49, s97, 0x20a000
    s_add_u32 m0, s96, 40960
    s_add_u32 s52, s97, 0x40a000
    buffer_load_dwordx4 v251, s[28:31], s49 offen sc1 lds
    s_add_u32 m0, s96, 106496
    s_nop 0
    buffer_load_dwordx4 v251, s[28:31], s52 offen sc1 lds
    s_add_u32 s49, s97, 0x20b000
    s_add_u32 m0, s96, 45056
    s_add_u32 s52, s97, 0x40b000
    buffer_load_dwordx4 v251, s[28:31], s49 offen sc1 lds
    s_add_u32 m0, s96, 110592
    s_nop 0
    buffer_load_dwordx4 v251, s[28:31], s52 offen sc1 lds
    s_add_u32 s49, s97, 0x20c000
    s_add_u32 m0, s96, 49152
    s_add_u32 s52, s97, 0x40c000
    buffer_load_dwordx4 v251, s[28:31], s49 offen sc1 lds
    s_add_u32 m0, s96, 114688
    s_nop 0
    buffer_load_dwordx4 v251, s[28:31], s52 offen sc1 lds
    s_add_u32 s49, s97, 0x20d000
    s_add_u32 m0, s96, 53248
    s_add_u32 s52, s97, 0x40d000
    buffer_load_dwordx4 v251, s[28:31], s49 offen sc1 lds
    s_add_u32 m0, s96, 118784
    s_nop 0
    buffer_load_dwordx4 v251, s[28:31], s52 offen sc1 lds
    s_add_u32 s49, s97, 0x20e000
    s_add_u32 m0, s96, 57344
    s_add_u32 s52, s97, 0x40e000
    buffer_load_dwordx4 v251, s[28:31], s49 offen sc1 lds
    s_add_u32 m0, s96, 122880
    s_nop 0
    buffer_load_dwordx4 v251, s[28:31], s52 offen sc1 lds
    s_add_u32 s49, s97, 0x20f000
    s_add_u32 m0, s96, 61440
    s_add_u32 s52, s97, 0x40f000
    buffer_load_dwordx4 v251, s[28:31], s49 offen sc1 lds
    s_add_u32 m0, s96, 126976
    s_nop 0
    buffer_load_dwordx4 v251, s[28:31], s52 offen sc1 lds
L7_nokv:
    s_lshl_b32 s49, s44, 3
    s_add_u32 s49, s49, s40
    s_lshl_b32 s51, s49, 5
    s_add_u32 s51, s51, s43
    s_lshl_b32 s51, s51, 3
    s_add_u32 s100, s51, 0xf08000
    s_lshl_b32 s49, s49, 15
    s_lshl_b32 s50, s43, 10
    s_add_u32 s49, s49, s50
    s_add_u32 s101, s49, 0x600000
    s_cmp_lt_u32 s40, 4
    s_cbranch_scc1 L8_px
    s_setprio 1
    s_mov_b32 s57, 82
    s_mov_b32 s99, 99
    s_branch L9_pd
L8_px:
    s_setprio 2
    s_mov_b32 s57, 254
    s_mov_b32 s99, 99
L9_pd:
    s_waitcnt lgkmcnt(0)
    v_mfma_f32_32x32x16_bf16 v[0:15], v[60:63], v[56:59], 0
    s_mov_b32 s53, 0
    s_nop 5
L10_aloop:
    s_bitcmp1_b32 s57, s53
    s_cbranch_scc1 L11_jobs
L12_n5:
    s_waitcnt lgkmcnt(0)
    v_mfma_f32_32x32x16_bf16 v[16:31], v[64:67], v[56:59], 0
    ds_read_b128 v[72:75], v108 offset:3072
    ds_read_b128 v[60:63], v108 offset:4096
    v_exp_f32 v0, v0
    v_exp_f32 v1, v1
    v_exp_f32 v2, v2
    v_exp_f32 v3, v3
    v_cvt_pk_bf16_f32 v32, v0, v1
    v_cvt_pk_bf16_f32 v33, v2, v3
    v_mfma_f32_32x32x16_bf16 v[40:55], v[104:107], v[36:39], v[40:55]
    s_mov_b64 exec, s[60:61]
    ds_read_b128 v[96:99], v109 offset:1536
    ds_read_b128 v[84:87], v109 offset:2048
    ds_read_b128 v[100:103], v109 offset:2560
    ds_read_b128 v[88:91], v109 offset:3072
    s_mov_b64 exec, -1
    v_exp_f32 v4, v4
    v_exp_f32 v5, v5
    v_exp_f32 v6, v6
    v_exp_f32 v7, v7
    v_cvt_pk_bf16_f32 v34, v4, v5
    v_cvt_pk_bf16_f32 v35, v6, v7
    v_exp_f32 v8, v8
    v_exp_f32 v9, v9
    v_mfma_f32_32x32x16_bf16 v[40:55], v[76:79], v[32:35], v[40:55]
    v_exp_f32 v10, v10
    v_exp_f32 v11, v11
    v_cvt_pk_bf16_f32 v36, v8, v9
    v_cvt_pk_bf16_f32 v37, v10, v11
    v_exp_f32 v12, v12
    v_exp_f32 v13, v13
    v_exp_f32 v14, v14
    v_exp_f32 v15, v15
    v_cvt_pk_bf16_f32 v38, v12, v13
    v_cvt_pk_bf16_f32 v39, v14, v15
    v_mfma_f32_32x32x16_bf16 v[0:15], v[68:71], v[56:59], 0
    v_exp_f32 v16, v16
    v_exp_f32 v17, v17
    v_exp_f32 v18, v18
    v_exp_f32 v19, v19
    v_cvt_pk_bf16_f32 v32, v16, v17
    v_cvt_pk_bf16_f32 v33, v18, v19
    v_mfma_f32_32x32x16_bf16 v[40:55], v[92:95], v[36:39], v[40:55]
    v_exp_f32 v20, v20
    v_exp_f32 v21, v21
    v_exp_f32 v22, v22
    v_exp_f32 v23, v23
    v_cvt_pk_bf16_f32 v34, v20, v21
    v_cvt_pk_bf16_f32 v35, v22, v23
    v_exp_f32 v24, v24
    v_exp_f32 v25, v25
    v_mfma_f32_32x32x16_bf16 v[40:55], v[80:83], v[32:35], v[40:55]
    v_exp_f32 v26, v26
    v_exp_f32 v27, v27
    v_cvt_pk_bf16_f32 v36, v24, v25
    v_cvt_pk_bf16_f32 v37, v26, v27
    v_exp_f32 v28, v28
    v_exp_f32 v29, v29
    v_exp_f32 v30, v30
    v_exp_f32 v31, v31
    v_cvt_pk_bf16_f32 v38, v28, v29
    v_cvt_pk_bf16_f32 v39, v30, v31
    s_waitcnt lgkmcnt(0)
    v_mfma_f32_32x32x16_bf16 v[16:31], v[72:75], v[56:59], 0
    ds_read_b128 v[64:67], v108 offset:5120
    ds_read_b128 v[68:71], v108 offset:6144
    v_exp_f32 v0, v0
    v_exp_f32 v1, v1
    v_exp_f32 v2, v2
    v_exp_f32 v3, v3
    v_cvt_pk_bf16_f32 v32, v0, v1
    v_cvt_pk_bf16_f32 v33, v2, v3
    v_mfma_f32_32x32x16_bf16 v[40:55], v[96:99], v[36:39], v[40:55]
    s_mov_b64 exec, s[60:61]
    ds_read_b128 v[104:107], v109 offset:3584
    ds_read_b128 v[76:79], v109 offset:4096
    ds_read_b128 v[92:95], v109 offset:4608
    ds_read_b128 v[80:83], v109 offset:5120
    s_mov_b64 exec, -1
    v_exp_f32 v4, v4
    v_exp_f32 v5, v5
    v_exp_f32 v6, v6
    v_exp_f32 v7, v7
    v_cvt_pk_bf16_f32 v34, v4, v5
    v_cvt_pk_bf16_f32 v35, v6, v7
    v_exp_f32 v8, v8
    v_exp_f32 v9, v9
    v_mfma_f32_32x32x16_bf16 v[40:55], v[84:87], v[32:35], v[40:55]
    v_exp_f32 v10, v10
    v_exp_f32 v11, v11
    v_cvt_pk_bf16_f32 v36, v8, v9
    v_cvt_pk_bf16_f32 v37, v10, v11
    v_exp_f32 v12, v12
    v_exp_f32 v13, v13
    v_exp_f32 v14, v14
    v_exp_f32 v15, v15
    v_cvt_pk_bf16_f32 v38, v12, v13
    v_cvt_pk_bf16_f32 v39, v14, v15
    v_mfma_f32_32x32x16_bf16 v[0:15], v[60:63], v[56:59], 0
    v_exp_f32 v16, v16
    v_exp_f32 v17, v17
    v_exp_f32 v18, v18
    v_exp_f32 v19, v19
    v_cvt_pk_bf16_f32 v32, v16, v17
    v_cvt_pk_bf16_f32 v33, v18, v19
    v_mfma_f32_32x32x16_bf16 v[40:55], v[100:103], v[36:39], v[40:55]
    v_exp_f32 v20, v20
    v_exp_f32 v21, v21
    v_exp_f32 v22, v22
    v_exp_f32 v23, v23
    v_cvt_pk_bf16_f32 v34, v20, v21
    v_cvt_pk_bf16_f32 v35, v22, v23
    v_exp_f32 v24, v24
    v_exp_f32 v25, v25
    v_mfma_f32_32x32x16_bf16 v[40:55], v[88:91], v[32:35], v[40:55]
    v_exp_f32 v26, v26
    v_exp_f32 v27, v27
    v_cvt_pk_bf16_f32 v36, v24, v25
    v_cvt_pk_bf16_f32 v37, v26, v27
    v_exp_f32 v28, v28
    v_exp_f32 v29, v29
    v_exp_f32 v30, v30
    v_exp_f32 v31, v31
    v_cvt_pk_bf16_f32 v38, v28, v29
    v_cvt_pk_bf16_f32 v39, v30, v31
    s_waitcnt lgkmcnt(0)
    v_mfma_f32_32x32x16_bf16 v[16:31], v[64:67], v[56:59], 0
    ds_read_b128 v[72:75], v108 offset:7168
    ds_read_b128 v[60:63], v108 offset:8192
    v_exp_f32 v0, v0
    v_exp_f32 v1, v1
    v_exp_f32 v2, v2
    v_exp_f32 v3, v3
    v_cvt_pk_bf16_f32 v32, v0, v1
    v_cvt_pk_bf16_f32 v33, v2, v3
    v_mfma_f32_32x32x16_bf16 v[40:55], v[104:107], v[36:39], v[40:55]
    s_mov_b64 exec, s[60:61]
    ds_read_b128 v[96:99], v109 offset:5632
    ds_read_b128 v[84:87], v109 offset:6144
    ds_read_b128 v[100:103], v109 offset:6656
    ds_read_b128 v[88:91], v109 offset:7168
    s_mov_b64 exec, -1
    v_exp_f32 v4, v4
    v_exp_f32 v5, v5
    v_exp_f32 v6, v6
    v_exp_f32 v7, v7
    v_cvt_pk_bf16_f32 v34, v4, v5
    v_cvt_pk_bf16_f32 v35, v6, v7
    v_exp_f32 v8, v8
    v_exp_f32 v9, v9
    v_mfma_f32_32x32x16_bf16 v[40:55], v[76:79], v[32:35], v[40:55]
    v_exp_f32 v10, v10
    v_exp_f32 v11, v11
    v_cvt_pk_bf16_f32 v36, v8, v9
    v_cvt_pk_bf16_f32 v37, v10, v11
    v_exp_f32 v12, v12
    v_exp_f32 v13, v13
    v_exp_f32 v14, v14
    v_exp_f32 v15, v15
    v_cvt_pk_bf16_f32 v38, v12, v13
    v_cvt_pk_bf16_f32 v39, v14, v15
    v_mfma_f32_32x32x16_bf16 v[0:15], v[68:71], v[56:59], 0
    v_exp_f32 v16, v16
    v_exp_f32 v17, v17
    v_exp_f32 v18, v18
    v_exp_f32 v19, v19
    v_cvt_pk_bf16_f32 v32, v16, v17
    v_cvt_pk_bf16_f32 v33, v18, v19
    v_mfma_f32_32x32x16_bf16 v[40:55], v[92:95], v[36:39], v[40:55]
    v_exp_f32 v20, v20
    v_exp_f32 v21, v21
    v_exp_f32 v22, v22
    v_exp_f32 v23, v23
    v_cvt_pk_bf16_f32 v34, v20, v21
    v_cvt_pk_bf16_f32 v35, v22, v23
    v_exp_f32 v24, v24
    v_exp_f32 v25, v25
    v_mfma_f32_32x32x16_bf16 v[40:55], v[80:83], v[32:35], v[40:55]
    v_exp_f32 v26, v26
    v_exp_f32 v27, v27
    v_cvt_pk_bf16_f32 v36, v24, v25
    v_cvt_pk_bf16_f32 v37, v26, v27
    v_exp_f32 v28, v28
    v_exp_f32 v29, v29
    v_exp_f32 v30, v30
    v_exp_f32 v31, v31
    v_cvt_pk_bf16_f32 v38, v28, v29
    v_cvt_pk_bf16_f32 v39, v30, v31
    s_waitcnt lgkmcnt(0)
    v_mfma_f32_32x32x16_bf16 v[16:31], v[72:75], v[56:59], 0
    ds_read_b128 v[64:67], v108 offset:9216
    ds_read_b128 v[68:71], v108 offset:10240
    v_exp_f32 v0, v0
    v_exp_f32 v1, v1
    v_exp_f32 v2, v2
    v_exp_f32 v3, v3
    v_cvt_pk_bf16_f32 v32, v0, v1
    v_cvt_pk_bf16_f32 v33, v2, v3
    v_mfma_f32_32x32x16_bf16 v[40:55], v[96:99], v[36:39], v[40:55]
    s_mov_b64 exec, s[60:61]
    ds_read_b128 v[104:107], v109 offset:7680
    ds_read_b128 v[76:79], v109 offset:8192
    ds_read_b128 v[92:95], v109 offset:8704
    ds_read_b128 v[80:83], v109 offset:9216
    s_mov_b64 exec, -1
    v_exp_f32 v4, v4
    v_exp_f32 v5, v5
    v_exp_f32 v6, v6
    v_exp_f32 v7, v7
    v_cvt_pk_bf16_f32 v34, v4, v5
    v_cvt_pk_bf16_f32 v35, v6, v7
    v_exp_f32 v8, v8
    v_exp_f32 v9, v9
    v_mfma_f32_32x32x16_bf16 v[40:55], v[84:87], v[32:35], v[40:55]
    v_exp_f32 v10, v10
    v_exp_f32 v11, v11
    v_cvt_pk_bf16_f32 v36, v8, v9
    v_cvt_pk_bf16_f32 v37, v10, v11
    v_exp_f32 v12, v12
    v_exp_f32 v13, v13
    v_exp_f32 v14, v14
    v_exp_f32 v15, v15
    v_cvt_pk_bf16_f32 v38, v12, v13
    v_cvt_pk_bf16_f32 v39, v14, v15
    v_mfma_f32_32x32x16_bf16 v[0:15], v[60:63], v[56:59], 0
    v_exp_f32 v16, v16
    v_exp_f32 v17, v17
    v_exp_f32 v18, v18
    v_exp_f32 v19, v19
    v_cvt_pk_bf16_f32 v32, v16, v17
    v_cvt_pk_bf16_f32 v33, v18, v19
    v_mfma_f32_32x32x16_bf16 v[40:55], v[100:103], v[36:39], v[40:55]
    v_exp_f32 v20, v20
    v_exp_f32 v21, v21
    v_exp_f32 v22, v22
    v_exp_f32 v23, v23
    v_cvt_pk_bf16_f32 v34, v20, v21
    v_cvt_pk_bf16_f32 v35, v22, v23
    v_exp_f32 v24, v24
    v_exp_f32 v25, v25
    v_mfma_f32_32x32x16_bf16 v[40:55], v[88:91], v[32:35], v[40:55]
    v_exp_f32 v26, v26
    v_exp_f32 v27, v27
    v_cvt_pk_bf16_f32 v36, v24, v25
    v_cvt_pk_bf16_f32 v37, v26, v27
    v_exp_f32 v28, v28
    v_exp_f32 v29, v29
    v_exp_f32 v30, v30
    v_exp_f32 v31, v31
    v_cvt_pk_bf16_f32 v38, v28, v29
    v_cvt_pk_bf16_f32 v39, v30, v31
    v_add_u32 v108, 8192, v108
    v_add_u32 v109, 8192, v109
    s_add_u32 s53, s53, 1
    s_cmp_lt_u32 s53, 8
    s_cbranch_scc1 L10_aloop
    s_waitcnt lgkmcnt(0)
    v_mfma_f32_32x32x16_bf16 v[40:55], v[104:107], v[36:39], v[40:55]
    s_setprio 0
    s_nop 15
    s_nop 7
    v_mul_f32 v110, 0, v40
    v_fma_f32 v110, v41, 0, v110
    v_fma_f32 v110, v42, 0, v110
    v_fma_f32 v110, v43, 0, v110
    v_fma_f32 v110, v44, 0, v110
    v_fma_f32 v110, v45, 0, v110
    v_fma_f32 v110, v46, 0, v110
    v_fma_f32 v110, v47, 0, v110
    s_mov_b32 s4, 0x1f800000
    s_mov_b32 s5, 0x5f800000
    v_cmp_eq_f32 vcc, 0, v110
    v_cmp_le_f32 s[6:7], s4, v48
    s_nop 1
    s_and_b64 vcc, vcc, s[6:7]
    v_cmp_ge_f32 s[6:7], s5, v48
    s_nop 1
    s_and_b64 vcc, vcc, s[6:7]
    s_cmp_eq_u64 vcc, -1
    s_cbranch_scc0 L16_slow
L15_ok:
    v_rcp_f32 v110, v48
    s_nop 0
    v_mul_f32 v40, v40, v110
    v_mul_f32 v41, v41, v110
    v_mul_f32 v42, v42, v110
    v_mul_f32 v43, v43, v110
    v_mul_f32 v44, v44, v110
    v_mul_f32 v45, v45, v110
    v_mul_f32 v46, v46, v110
    v_mul_f32 v47, v47, v110
    v_cvt_pk_bf16_f32 v32, v40, v41
    v_cvt_pk_bf16_f32 v33, v42, v43
    v_cvt_pk_bf16_f32 v34, v44, v45
    v_cvt_pk_bf16_f32 v35, v46, v47
    buffer_store_dwordx4 v[32:35], v251, s[28:31], s101 offen sc1
    s_cmp_lt_u32 s40, 4
    s_cbranch_scc1 L17_bcons
    s_waitcnt vmcnt(5)
    s_barrier
    s_waitcnt vmcnt(1)
    s_barrier
    s_add_u32 m0, s98, 0
    s_mov_b32 s55, 262144
    buffer_load_dwordx4 v242, s[20:23], s55 offen lds
    s_add_u32 m0, s98, 1024
    s_nop 0
    buffer_load_dwordx4 v243, s[20:23], s55 offen lds
    s_add_u32 m0, s98, 8192
    s_mov_b32 s55, 327680
    buffer_load_dwordx4 v242, s[20:23], s55 offen lds
    s_add_u32 m0, s98, 9216
    s_nop 0
    buffer_load_dwordx4 v243, s[20:23], s55 offen lds
    s_add_u32 m0, s98, 16384
    s_mov_b32 s55, 393216
    buffer_load_dwordx4 v242, s[20:23], s55 offen lds
    s_add_u32 m0, s98, 17408
    s_nop 0
    buffer_load_dwordx4 v243, s[20:23], s55 offen lds
    s_add_u32 m0, s98, 24576
    s_mov_b32 s55, 458752
    buffer_load_dwordx4 v242, s[20:23], s55 offen lds
    s_add_u32 m0, s98, 25600
    s_nop 0
    buffer_load_dwordx4 v243, s[20:23], s55 offen lds
    s_waitcnt vmcnt(4)
    s_barrier
    s_add_u32 m0, s98, 32768
    s_mov_b32 s55, 524288
    buffer_load_dwordx4 v242, s[20:23], s55 offen lds
    s_add_u32 m0, s98, 33792
    s_nop 0
    buffer_load_dwordx4 v243, s[20:23], s55 offen lds
    s_add_u32 m0, s98, 40960
    s_mov_b32 s55, 589824
    buffer_load_dwordx4 v242, s[20:23], s55 offen lds
    s_add_u32 m0, s98, 41984
    s_nop 0
    buffer_load_dwordx4 v243, s[20:23], s55 offen lds
    s_mov_b64 exec, 1
    buffer_store_dwordx2 v[248:249], v247, s[28:31], s100 offen sc1
    s_mov_b64 exec, -1
    s_waitcnt vmcnt(5)
    s_barrier
    s_add_u32 m0, s98, 49152
    s_mov_b32 s55, 655360
    buffer_load_dwordx4 v242, s[20:23], s55 offen lds
    s_add_u32 m0, s98, 50176
    s_nop 0
    buffer_load_dwordx4 v243, s[20:23], s55 offen lds
    s_add_u32 m0, s98, 57344
    s_mov_b32 s55, 720896
    buffer_load_dwordx4 v242, s[20:23], s55 offen lds
    s_add_u32 m0, s98, 58368
    s_nop 0
    buffer_load_dwordx4 v243, s[20:23], s55 offen lds
    s_waitcnt vmcnt(5)
    s_barrier
    s_add_u32 m0, s98, 65536
    s_mov_b32 s55, 786432
    buffer_load_dwordx4 v242, s[20:23], s55 offen lds
    s_add_u32 m0, s98, 66560
    s_nop 0
    buffer_load_dwordx4 v243, s[20:23], s55 offen lds
    s_add_u32 m0, s98, 73728
    s_mov_b32 s55, 851968
    buffer_load_dwordx4 v242, s[20:23], s55 offen lds
    s_add_u32 m0, s98, 74752
    s_nop 0
    buffer_load_dwordx4 v243, s[20:23], s55 offen lds
    s_waitcnt vmcnt(4)
    s_barrier
    s_add_u32 m0, s98, 81920
    s_mov_b32 s55, 917504
    buffer_load_dwordx4 v242, s[20:23], s55 offen lds
    s_add_u32 m0, s98, 82944
    s_nop 0
    buffer_load_dwordx4 v243, s[20:23], s55 offen lds
    s_add_u32 m0, s98, 90112
    s_mov_b32 s55, 983040
    buffer_load_dwordx4 v242, s[20:23], s55 offen lds
    s_add_u32 m0, s98, 91136
    s_nop 0
    buffer_load_dwordx4 v243, s[20:23], s55 offen lds
    s_waitcnt vmcnt(4)
    s_barrier
    s_add_u32 m0, s98, 98304
    s_mov_b32 s55, 1048576
    buffer_load_dwordx4 v242, s[20:23], s55 offen lds
    s_add_u32 m0, s98, 99328
    s_nop 0
    buffer_load_dwordx4 v243, s[20:23], s55 offen lds
    s_add_u32 m0, s98, 106496
    s_mov_b32 s55, 1114112
    buffer_load_dwordx4 v242, s[20:23], s55 offen lds
    s_add_u32 m0, s98, 107520
    s_nop 0
    buffer_load_dwordx4 v243, s[20:23], s55 offen lds
    s_waitcnt vmcnt(4)
    s_barrier
    s_add_u32 m0, s98, 114688
    s_mov_b32 s55, 1179648
    buffer_load_dwordx4 v242, s[20:23], s55 offen lds
    s_add_u32 m0, s98, 115712
    s_nop 0
    buffer_load_dwordx4 v243, s[20:23], s55 offen lds
    s_add_u32 m0, s98, 122880
    s_mov_b32 s55, 1245184
    buffer_load_dwordx4 v242, s[20:23], s55 offen lds
    s_add_u32 m0, s98, 123904
    s_nop 0
    buffer_load_dwordx4 v243, s[20:23], s55 offen lds
    s_waitcnt vmcnt(4)
    s_barrier
    s_add_u32 m0, s98, 131072
    s_mov_b32 s55, 1310720
    buffer_load_dwordx4 v242, s[20:23], s55 offen lds
    s_add_u32 m0, s98, 132096
    s_nop 0
    buffer_load_dwordx4 v243, s[20:23], s55 offen lds
    s_add_u32 m0, s98, 139264
    s_mov_b32 s55, 1376256
    buffer_load_dwordx4 v242, s[20:23], s55 offen lds
    s_add_u32 m0, s98, 140288
    s_nop 0
    buffer_load_dwordx4 v243, s[20:23], s55 offen lds
    s_waitcnt vmcnt(4)
    s_barrier
    s_add_u32 m0, s98, 147456
    s_mov_b32 s55, 0
    buffer_load_dwordx4 v242, s[24:27], s55 offen lds
    s_add_u32 m0, s98, 148480
    s_nop 0
    buffer_load_dwordx4 v243, s[24:27], s55 offen lds
    s_add_u32 m0, s98, 155648
    s_mov_b32 s55, 65536
    buffer_load_dwordx4 v242, s[24:27], s55 offen lds
    s_add_u32 m0, s98, 156672
    s_nop 0
    buffer_load_dwordx4 v243, s[24:27], s55 offen lds
    s_waitcnt vmcnt(4)
    s_barrier
    s_add_u32 m0, s98, 0
    s_mov_b32 s55, 131072
    buffer_load_dwordx4 v242, s[24:27], s55 offen lds
    s_add_u32 m0, s98, 1024
    s_nop 0
    buffer_load_dwordx4 v243, s[24:27], s55 offen lds
    s_add_u32 m0, s98, 8192
    s_mov_b32 s55, 196608
    buffer_load_dwordx4 v242, s[24:27], s55 offen lds
    s_add_u32 m0, s98, 9216
    s_nop 0
    buffer_load_dwordx4 v243, s[24:27], s55 offen lds
    s_waitcnt vmcnt(4)
    s_barrier
    s_add_u32 m0, s98, 16384
    s_mov_b32 s55, 262144
    buffer_load_dwordx4 v242, s[24:27], s55 offen lds
    s_add_u32 m0, s98, 17408
    s_nop 0
    buffer_load_dwordx4 v243, s[24:27], s55 offen lds
    s_add_u32 m0, s98, 24576
    s_mov_b32 s55, 327680
    buffer_load_dwordx4 v242, s[24:27], s55 offen lds
    s_add_u32 m0, s98, 25600
    s_nop 0
    buffer_load_dwordx4 v243, s[24:27], s55 offen lds
    s_waitcnt vmcnt(4)
    s_barrier
    s_add_u32 m0, s98, 32768
    s_mov_b32 s55, 393216
    buffer_load_dwordx4 v242, s[24:27], s55 offen lds
    s_add_u32 m0, s98, 33792
    s_nop 0
    buffer_load_dwordx4 v243, s[24:27], s55 offen lds
    s_add_u32 m0, s98, 40960
    s_mov_b32 s55, 458752
    buffer_load_dwordx4 v242, s[24:27], s55 offen lds
    s_add_u32 m0, s98, 41984
    s_nop 0
    buffer_load_dwordx4 v243, s[24:27], s55 offen lds
    s_waitcnt vmcnt(4)
    s_barrier
    s_waitcnt vmcnt(0)
    s_barrier
    s_barrier
    s_endpgm
L17_bcons:
    v_lshrrev_b32 v118, 5, v250
    v_lshlrev_b32 v118, 2, v118
    v_bfe_u32 v119, v250, 2, 2
    v_add_u32 v118, v118, v119
    s_lshr_b32 s50, s40, 1
    s_lshl_b32 s50, s50, 5
    v_add_u32 v118, s50, v118
    v_lshlrev_b32 v118, 7, v118
    v_bfe_u32 v119, v250, 3, 1
    v_lshlrev_b32 v119, 6, v119
    v_add_u32 v118, v118, v119
    v_bfe_u32 v119, v250, 4, 1
    v_lshlrev_b32 v119, 5, v119
    v_add_u32 v118, v118, v119
    v_and_b32 v119, 3, v250
    v_lshlrev_b32 v119, 3, v119
    v_add_u32 v114, v118, v119
    v_xor_b32 v115, 64, v114
    s_barrier
    v_add_u32 v112, 131072, v114
    v_add_u32 v113, 131072, v115
    ds_read_b64_tr_b16 v[64:65], v112 offset:0
    ds_read_b64_tr_b16 v[66:67], v112 offset:1024
    ds_read_b64_tr_b16 v[68:69], v113 offset:0
    ds_read_b64_tr_b16 v[70:71], v113 offset:1024
    ds_read_b64_tr_b16 v[72:73], v112 offset:2048
    ds_read_b64_tr_b16 v[74:75], v112 offset:3072
    ds_read_b64_tr_b16 v[76:77], v113 offset:2048
    ds_read_b64_tr_b16 v[78:79], v113 offset:3072
    v_add_u32 v112, 139264, v114
    v_add_u32 v113, 139264, v115
    ds_read_b64_tr_b16 v[80:81], v112 offset:0
    ds_read_b64_tr_b16 v[82:83], v112 offset:1024
    ds_read_b64_tr_b16 v[84:85], v113 offset:0
    ds_read_b64_tr_b16 v[86:87], v113 offset:1024
    ds_read_b64_tr_b16 v[88:89], v112 offset:2048
    ds_read_b64_tr_b16 v[90:91], v112 offset:3072
    s_waitcnt lgkmcnt(13)
    ds_read_b64_tr_b16 v[92:93], v113 offset:2048
    ds_read_b64_tr_b16 v[94:95], v113 offset:3072
    s_barrier
    v_add_u32 v112, 147456, v114
    v_add_u32 v113, 147456, v115
    s_waitcnt lgkmcnt(8)
    s_waitcnt vmcnt(29)
    v_mfma_f32_32x32x16_bf16 v[0:15], v[64:67], v[120:123], 0
    ds_read_b64_tr_b16 v[96:97], v112 offset:0
    ds_read_b64_tr_b16 v[98:99], v112 offset:1024
    v_mfma_f32_32x32x16_bf16 v[16:31], v[68:71], v[120:123], 0
    ds_read_b64_tr_b16 v[100:101], v113 offset:0
    ds_read_b64_tr_b16 v[102:103], v113 offset:1024
    v_mfma_f32_32x32x16_bf16 v[0:15], v[72:75], v[124:127], v[0:15]
    ds_read_b64_tr_b16 v[104:105], v112 offset:2048
    ds_read_b64_tr_b16 v[106:107], v112 offset:3072
    v_mfma_f32_32x32x16_bf16 v[16:31], v[76:79], v[124:127], v[16:31]
    s_waitcnt lgkmcnt(13)
    ds_read_b64_tr_b16 v[108:109], v113 offset:2048
    ds_read_b64_tr_b16 v[110:111], v113 offset:3072
    s_add_u32 s49, s96, 61440
    buffer_load_dwordx4 v[120:123], v251, s[28:31], s49 offen sc1
    buffer_load_dwordx4 v[124:127], v251, s[28:31], s49 offen offset:1024 sc1
    v_add_u32 v112, 155648, v114
    v_add_u32 v113, 155648, v115
    s_waitcnt lgkmcnt(8)
    s_waitcnt vmcnt(29)
    v_mfma_f32_32x32x16_bf16 v[0:15], v[80:83], v[128:131], v[0:15]
    ds_read_b64_tr_b16 v[64:65], v112 offset:0
    ds_read_b64_tr_b16 v[66:67], v112 offset:1024
    v_mfma_f32_32x32x16_bf16 v[16:31], v[84:87], v[128:131], v[16:31]
    ds_read_b64_tr_b16 v[68:69], v113 offset:0
    ds_read_b64_tr_b16 v[70:71], v113 offset:1024
    v_mfma_f32_32x32x16_bf16 v[0:15], v[88:91], v[132:135], v[0:15]
    ds_read_b64_tr_b16 v[72:73], v112 offset:2048
    ds_read_b64_tr_b16 v[74:75], v112 offset:3072
    v_mfma_f32_32x32x16_bf16 v[16:31], v[92:95], v[132:135], v[16:31]
    s_waitcnt lgkmcnt(13)
    ds_read_b64_tr_b16 v[76:77], v113 offset:2048
    ds_read_b64_tr_b16 v[78:79], v113 offset:3072
    s_add_u32 s49, s96, 65536
    buffer_load_dwordx4 v[128:131], v251, s[28:31], s49 offen sc1
    buffer_load_dwordx4 v[132:135], v251, s[28:31], s49 offen offset:1024 sc1
    s_waitcnt vmcnt(4)
    s_mov_b64 exec, 1
    buffer_store_dwordx2 v[248:249], v247, s[28:31], s100 offen sc1
    s_mov_b64 exec, -1
    s_barrier
    v_add_u32 v112, 0, v114
    v_add_u32 v113, 0, v115
    s_waitcnt lgkmcnt(8)
    v_mfma_f32_32x32x16_bf16 v[0:15], v[96:99], v[136:139], v[0:15]
    ds_read_b64_tr_b16 v[80:81], v112 offset:0
    ds_read_b64_tr_b16 v[82:83], v112 offset:1024
    v_mfma_f32_32x32x16_bf16 v[16:31], v[100:103], v[136:139], v[16:31]
    ds_read_b64_tr_b16 v[84:85], v113 offset:0
    ds_read_b64_tr_b16 v[86:87], v113 offset:1024
    v_mfma_f32_32x32x16_bf16 v[0:15], v[104:107], v[140:143], v[0:15]
    ds_read_b64_tr_b16 v[88:89], v112 offset:2048
    ds_read_b64_tr_b16 v[90:91], v112 offset:3072
    v_mfma_f32_32x32x16_bf16 v[16:31], v[108:111], v[140:143], v[16:31]
    s_waitcnt lgkmcnt(13)
    ds_read_b64_tr_b16 v[92:93], v113 offset:2048
    ds_read_b64_tr_b16 v[94:95], v113 offset:3072
    v_add_u32 v112, 8192, v114
    v_add_u32 v113, 8192, v115
    s_waitcnt lgkmcnt(8)
    v_mfma_f32_32x32x16_bf16 v[0:15], v[64:67], v[144:147], v[0:15]
    ds_read_b64_tr_b16 v[96:97], v112 offset:0
    ds_read_b64_tr_b16 v[98:99], v112 offset:1024
    v_mfma_f32_32x32x16_bf16 v[16:31], v[68:71], v[144:147], v[16:31]
    ds_read_b64_tr_b16 v[100:101], v113 offset:0
    ds_read_b64_tr_b16 v[102:103], v113 offset:1024
    v_mfma_f32_32x32x16_bf16 v[0:15], v[72:75], v[148:151], v[0:15]
    ds_read_b64_tr_b16 v[104:105], v112 offset:2048
    ds_read_b64_tr_b16 v[106:107], v112 offset:3072
    v_mfma_f32_32x32x16_bf16 v[16:31], v[76:79], v[148:151], v[16:31]
    s_waitcnt lgkmcnt(13)
    ds_read_b64_tr_b16 v[108:109], v113 offset:2048
    ds_read_b64_tr_b16 v[110:111], v113 offset:3072
    s_add_u32 s49, s96, 69632
    buffer_load_dwordx4 v[136:139], v251, s[28:31], s49 offen sc1
    buffer_load_dwordx4 v[140:143], v251, s[28:31], s49 offen offset:1024 sc1
    s_barrier
    v_add_u32 v112, 16384, v114
    v_add_u32 v113, 16384, v115
    s_waitcnt lgkmcnt(8)
    v_mfma_f32_32x32x16_bf16 v[0:15], v[80:83], v[152:155], v[0:15]
    ds_read_b64_tr_b16 v[64:65], v112 offset:0
    ds_read_b64_tr_b16 v[66:67], v112 offset:1024
    v_mfma_f32_32x32x16_bf16 v[16:31], v[84:87], v[152:155], v[16:31]
    ds_read_b64_tr_b16 v[68:69], v113 offset:0
    ds_read_b64_tr_b16 v[70:71], v113 offset:1024
    v_mfma_f32_32x32x16_bf16 v[0:15], v[88:91], v[156:159], v[0:15]
    ds_read_b64_tr_b16 v[72:73], v112 offset:2048
    ds_read_b64_tr_b16 v[74:75], v112 offset:3072
    v_mfma_f32_32x32x16_bf16 v[16:31], v[92:95], v[156:159], v[16:31]
    s_waitcnt lgkmcnt(13)
    ds_read_b64_tr_b16 v[76:77], v113 offset:2048
    ds_read_b64_tr_b16 v[78:79], v113 offset:3072
    s_add_u32 s49, s96, 73728
    buffer_load_dwordx4 v[144:147], v251, s[28:31], s49 offen sc1
    buffer_load_dwordx4 v[148:151], v251, s[28:31], s49 offen offset:1024 sc1
    v_add_u32 v112, 24576, v114
    v_add_u32 v113, 24576, v115
    s_waitcnt lgkmcnt(8)
    v_mfma_f32_32x32x16_bf16 v[0:15], v[96:99], v[160:163], v[0:15]
    ds_read_b64_tr_b16 v[80:81], v112 offset:0
    ds_read_b64_tr_b16 v[82:83], v112 offset:1024
    v_mfma_f32_32x32x16_bf16 v[16:31], v[100:103], v[160:163], v[16:31]
    ds_read_b64_tr_b16 v[84:85], v113 offset:0
    ds_read_b64_tr_b16 v[86:87], v113 offset:1024
    v_mfma_f32_32x32x16_bf16 v[0:15], v[104:107], v[164:167], v[0:15]
    ds_read_b64_tr_b16 v[88:89], v112 offset:2048
    ds_read_b64_tr_b16 v[90:91], v112 offset:3072
    v_mfma_f32_32x32x16_bf16 v[16:31], v[108:111], v[164:167], v[16:31]
    s_waitcnt lgkmcnt(13)
    ds_read_b64_tr_b16 v[92:93], v113 offset:2048
    ds_read_b64_tr_b16 v[94:95], v113 offset:3072
    s_barrier
    v_add_u32 v112, 32768, v114
    v_add_u32 v113, 32768, v115
    s_waitcnt lgkmcnt(8)
    v_mfma_f32_32x32x16_bf16 v[0:15], v[64:67], v[168:171], v[0:15]
    ds_read_b64_tr_b16 v[96:97], v112 offset:0
    ds_read_b64_tr_b16 v[98:99], v112 offset:1024
    v_mfma_f32_32x32x16_bf16 v[16:31], v[68:71], v[168:171], v[16:31]
    ds_read_b64_tr_b16 v[100:101], v113 offset:0
    ds_read_b64_tr_b16 v[102:103], v113 offset:1024
    v_mfma_f32_32x32x16_bf16 v[0:15], v[72:75], v[172:175], v[0:15]
    ds_read_b64_tr_b16 v[104:105], v112 offset:2048
    ds_read_b64_tr_b16 v[106:107], v112 offset:3072
    v_mfma_f32_32x32x16_bf16 v[16:31], v[76:79], v[172:175], v[16:31]
    s_waitcnt lgkmcnt(13)
    ds_read_b64_tr_b16 v[108:109], v113 offset:2048
    ds_read_b64_tr_b16 v[110:111], v113 offset:3072
    s_add_u32 s49, s96, 77824
    buffer_load_dwordx4 v[152:155], v251, s[28:31], s49 offen sc1
    buffer_load_dwordx4 v[156:159], v251, s[28:31], s49 offen offset:1024 sc1
    v_add_u32 v112, 40960, v114
    v_add_u32 v113, 40960, v115
    s_waitcnt lgkmcnt(8)
    v_mfma_f32_32x32x16_bf16 v[0:15], v[80:83], v[176:179], v[0:15]
    ds_read_b64_tr_b16 v[64:65], v112 offset:0
    ds_read_b64_tr_b16 v[66:67], v112 offset:1024
    v_mfma_f32_32x32x16_bf16 v[16:31], v[84:87], v[176:179], v[16:31]
    ds_read_b64_tr_b16 v[68:69], v113 offset:0
    ds_read_b64_tr_b16 v[70:71], v113 offset:1024
    v_mfma_f32_32x32x16_bf16 v[0:15], v[88:91], v[180:183], v[0:15]
    ds_read_b64_tr_b16 v[72:73], v112 offset:2048
    ds_read_b64_tr_b16 v[74:75], v112 offset:3072
    v_mfma_f32_32x32x16_bf16 v[16:31], v[92:95], v[180:183], v[16:31]
    s_waitcnt lgkmcnt(13)
    ds_read_b64_tr_b16 v[76:77], v113 offset:2048
    ds_read_b64_tr_b16 v[78:79], v113 offset:3072
    s_add_u32 s49, s96, 81920
    buffer_load_dwordx4 v[160:163], v251, s[28:31], s49 offen sc1
    buffer_load_dwordx4 v[164:167], v251, s[28:31], s49 offen offset:1024 sc1
    s_barrier
    v_add_u32 v112, 49152, v114
    v_add_u32 v113, 49152, v115
    s_waitcnt lgkmcnt(8)
    v_mfma_f32_32x32x16_bf16 v[0:15], v[96:99], v[184:187], v[0:15]
    ds_read_b64_tr_b16 v[80:81], v112 offset:0
    ds_read_b64_tr_b16 v[82:83], v112 offset:1024
    v_mfma_f32_32x32x16_bf16 v[16:31], v[100:103], v[184:187], v[16:31]
    ds_read_b64_tr_b16 v[84:85], v113 offset:0
    ds_read_b64_tr_b16 v[86:87], v113 offset:1024
    v_mfma_f32_32x32x16_bf16 v[0:15], v[104:107], v[188:191], v[0:15]
    ds_read_b64_tr_b16 v[88:89], v112 offset:2048
    ds_read_b64_tr_b16 v[90:91], v112 offset:3072
    v_mfma_f32_32x32x16_bf16 v[16:31], v[108:111], v[188:191], v[16:31]
    s_waitcnt lgkmcnt(13)
    ds_read_b64_tr_b16 v[92:93], v113 offset:2048
    ds_read_b64_tr_b16 v[94:95], v113 offset:3072
    v_add_u32 v112, 57344, v114
    v_add_u32 v113, 57344, v115
    s_waitcnt lgkmcnt(8)
    v_mfma_f32_32x32x16_bf16 v[0:15], v[64:67], v[192:195], v[0:15]
    ds_read_b64_tr_b16 v[96:97], v112 offset:0
    ds_read_b64_tr_b16 v[98:99], v112 offset:1024
    v_mfma_f32_32x32x16_bf16 v[16:31], v[68:71], v[192:195], v[16:31]
    ds_read_b64_tr_b16 v[100:101], v113 offset:0
    ds_read_b64_tr_b16 v[102:103], v113 offset:1024
    v_mfma_f32_32x32x16_bf16 v[0:15], v[72:75], v[196:199], v[0:15]
    ds_read_b64_tr_b16 v[104:105], v112 offset:2048
    ds_read_b64_tr_b16 v[106:107], v112 offset:3072
    v_mfma_f32_32x32x16_bf16 v[16:31], v[76:79], v[196:199], v[16:31]
    s_waitcnt lgkmcnt(13)
    ds_read_b64_tr_b16 v[108:109], v113 offset:2048
    ds_read_b64_tr_b16 v[110:111], v113 offset:3072
    s_add_u32 s49, s96, 86016
    buffer_load_dwordx4 v[168:171], v251, s[28:31], s49 offen sc1
    buffer_load_dwordx4 v[172:175], v251, s[28:31], s49 offen offset:1024 sc1
    s_barrier
    v_add_u32 v112, 65536, v114
    v_add_u32 v113, 65536, v115
    s_waitcnt lgkmcnt(8)
    v_mfma_f32_32x32x16_bf16 v[0:15], v[80:83], v[200:203], v[0:15]
    ds_read_b64_tr_b16 v[64:65], v112 offset:0
    ds_read_b64_tr_b16 v[66:67], v112 offset:1024
    v_mfma_f32_32x32x16_bf16 v[16:31], v[84:87], v[200:203], v[16:31]
    ds_read_b64_tr_b16 v[68:69], v113 offset:0
    ds_read_b64_tr_b16 v[70:71], v113 offset:1024
    v_mfma_f32_32x32x16_bf16 v[0:15], v[88:91], v[204:207], v[0:15]
    ds_read_b64_tr_b16 v[72:73], v112 offset:2048
    ds_read_b64_tr_b16 v[74:75], v112 offset:3072
    v_mfma_f32_32x32x16_bf16 v[16:31], v[92:95], v[204:207], v[16:31]
    s_waitcnt lgkmcnt(13)
    ds_read_b64_tr_b16 v[76:77], v113 offset:2048
    ds_read_b64_tr_b16 v[78:79], v113 offset:3072
    s_lshl_b32 s54, s45, 1
    s_and_b32 s49, s40, 1
    s_add_u32 s54, s54, s49
    s_lshl_b32 s54, s54, 8
    s_add_u32 s54, s54, 0xf08000
    s_mov_b32 s63, 0
    buffer_load_dwordx2 v[244:245], v246, s[28:31], s54 offen sc1
    v_add_u32 v112, 73728, v114
    v_add_u32 v113, 73728, v115
    s_waitcnt lgkmcnt(8)
    v_mfma_f32_32x32x16_bf16 v[0:15], v[96:99], v[208:211], v[0:15]
    ds_read_b64_tr_b16 v[80:81], v112 offset:0
    ds_read_b64_tr_b16 v[82:83], v112 offset:1024
    v_mfma_f32_32x32x16_bf16 v[16:31], v[100:103], v[208:211], v[16:31]
    ds_read_b64_tr_b16 v[84:85], v113 offset:0
    ds_read_b64_tr_b16 v[86:87], v113 offset:1024
    v_mfma_f32_32x32x16_bf16 v[0:15], v[104:107], v[212:215], v[0:15]
    ds_read_b64_tr_b16 v[88:89], v112 offset:2048
    ds_read_b64_tr_b16 v[90:91], v112 offset:3072
    v_mfma_f32_32x32x16_bf16 v[16:31], v[108:111], v[212:215], v[16:31]
    s_waitcnt lgkmcnt(13)
    ds_read_b64_tr_b16 v[92:93], v113 offset:2048
    ds_read_b64_tr_b16 v[94:95], v113 offset:3072
    s_barrier
    v_add_u32 v112, 81920, v114
    v_add_u32 v113, 81920, v115
    s_waitcnt lgkmcnt(8)
    v_mfma_f32_32x32x16_bf16 v[0:15], v[64:67], v[216:219], v[0:15]
    ds_read_b64_tr_b16 v[96:97], v112 offset:0
    ds_read_b64_tr_b16 v[98:99], v112 offset:1024
    v_mfma_f32_32x32x16_bf16 v[16:31], v[68:71], v[216:219], v[16:31]
    ds_read_b64_tr_b16 v[100:101], v113 offset:0
    ds_read_b64_tr_b16 v[102:103], v113 offset:1024
    v_mfma_f32_32x32x16_bf16 v[0:15], v[72:75], v[220:223], v[0:15]
    ds_read_b64_tr_b16 v[104:105], v112 offset:2048
    ds_read_b64_tr_b16 v[106:107], v112 offset:3072
    v_mfma_f32_32x32x16_bf16 v[16:31], v[76:79], v[220:223], v[16:31]
    s_waitcnt lgkmcnt(13)
    ds_read_b64_tr_b16 v[108:109], v113 offset:2048
    ds_read_b64_tr_b16 v[110:111], v113 offset:3072
    v_add_u32 v112, 90112, v114
    v_add_u32 v113, 90112, v115
    s_waitcnt lgkmcnt(8)
    v_mfma_f32_32x32x16_bf16 v[0:15], v[80:83], v[224:227], v[0:15]
    ds_read_b64_tr_b16 v[64:65], v112 offset:0
    ds_read_b64_tr_b16 v[66:67], v112 offset:1024
    v_mfma_f32_32x32x16_bf16 v[16:31], v[84:87], v[224:227], v[16:31]
    ds_read_b64_tr_b16 v[68:69], v113 offset:0
    ds_read_b64_tr_b16 v[70:71], v113 offset:1024
    v_mfma_f32_32x32x16_bf16 v[0:15], v[88:91], v[228:231], v[0:15]
    ds_read_b64_tr_b16 v[72:73], v112 offset:2048
    ds_read_b64_tr_b16 v[74:75], v112 offset:3072
    v_mfma_f32_32x32x16_bf16 v[16:31], v[92:95], v[228:231], v[16:31]
    s_waitcnt lgkmcnt(13)
    ds_read_b64_tr_b16 v[76:77], v113 offset:2048
    ds_read_b64_tr_b16 v[78:79], v113 offset:3072
    s_barrier
    v_add_u32 v112, 98304, v114
    v_add_u32 v113, 98304, v115
    s_waitcnt lgkmcnt(8)
    v_mfma_f32_32x32x16_bf16 v[0:15], v[96:99], v[232:235], v[0:15]
    ds_read_b64_tr_b16 v[80:81], v112 offset:0
    ds_read_b64_tr_b16 v[82:83], v112 offset:1024
    v_mfma_f32_32x32x16_bf16 v[16:31], v[100:103], v[232:235], v[16:31]
    ds_read_b64_tr_b16 v[84:85], v113 offset:0
    ds_read_b64_tr_b16 v[86:87], v113 offset:1024
    v_mfma_f32_32x32x16_bf16 v[0:15], v[104:107], v[236:239], v[0:15]
    ds_read_b64_tr_b16 v[88:89], v112 offset:2048
    ds_read_b64_tr_b16 v[90:91], v112 offset:3072
    v_mfma_f32_32x32x16_bf16 v[16:31], v[108:111], v[236:239], v[16:31]
    s_waitcnt lgkmcnt(13)
    ds_read_b64_tr_b16 v[92:93], v113 offset:2048
    ds_read_b64_tr_b16 v[94:95], v113 offset:3072
    s_cmp_lg_u32 s63, 0
    s_cbranch_scc1 L18_odone
    s_mov_b32 s6, 0
    s_mov_b32 s7, -1
    s_waitcnt vmcnt(0)
    v_cmp_eq_u32 vcc, s47, v244
    v_cmp_eq_u32 s[4:5], s48, v245
    s_nop 1
    s_and_b64 vcc, vcc, s[4:5]
    s_or_b64 vcc, vcc, s[6:7]
    s_cmp_eq_u64 vcc, -1
    s_cbranch_scc1 L19_ohit
    buffer_load_dwordx2 v[244:245], v246, s[28:31], s54 offen sc1
    s_branch L18_odone
L19_ohit:
    s_mov_b32 s63, 1
    s_lshl_b32 s49, s45, 1
    s_and_b32 s50, s40, 1
    s_add_u32 s49, s49, s50
    s_lshl_b32 s49, s49, 5
    v_and_b32 v118, 31, v250
    v_add_u32 v118, s49, v118
    v_lshlrev_b32 v117, 10, v118
    v_lshlrev_b32 v118, 2, v118
    v_add_u32 v118, 0x800000, v118
    buffer_load_dword v116, v118, s[28:31], 0 offen sc1
L18_odone:
    s_cmp_eq_u32 s63, 0
    s_cbranch_scc1 L20_osk
    s_add_u32 s49, s97, 0
    buffer_load_dwordx4 v[176:179], v251, s[28:31], s49 offen sc1
    buffer_load_dwordx4 v[180:183], v251, s[28:31], s49 offen offset:1024 sc1
L20_osk:
    v_add_u32 v112, 106496, v114
    v_add_u32 v113, 106496, v115
    s_waitcnt lgkmcnt(8)
    v_mfma_f32_32x32x16_bf16 v[0:15], v[64:67], v[120:123], v[0:15]
    ds_read_b64_tr_b16 v[96:97], v112 offset:0
    ds_read_b64_tr_b16 v[98:99], v112 offset:1024
    v_mfma_f32_32x32x16_bf16 v[16:31], v[68:71], v[120:123], v[16:31]
    ds_read_b64_tr_b16 v[100:101], v113 offset:0
    ds_read_b64_tr_b16 v[102:103], v113 offset:1024
    v_mfma_f32_32x32x16_bf16 v[0:15], v[72:75], v[124:127], v[0:15]
    ds_read_b64_tr_b16 v[104:105], v112 offset:2048
    ds_read_b64_tr_b16 v[106:107], v112 offset:3072
    v_mfma_f32_32x32x16_bf16 v[16:31], v[76:79], v[124:127], v[16:31]
    s_waitcnt lgkmcnt(13)
    ds_read_b64_tr_b16 v[108:109], v113 offset:2048
    ds_read_b64_tr_b16 v[110:111], v113 offset:3072
    s_cmp_eq_u32 s63, 0
    s_cbranch_scc1 L21_osk
    s_add_u32 s49, s97, 4096
    buffer_load_dwordx4 v[184:187], v251, s[28:31], s49 offen sc1
    buffer_load_dwordx4 v[188:191], v251, s[28:31], s49 offen offset:1024 sc1
L21_osk:
    s_barrier
    v_add_u32 v112, 114688, v114
    v_add_u32 v113, 114688, v115
    s_waitcnt lgkmcnt(8)
    v_mfma_f32_32x32x16_bf16 v[0:15], v[80:83], v[128:131], v[0:15]
    ds_read_b64_tr_b16 v[64:65], v112 offset:0
    ds_read_b64_tr_b16 v[66:67], v112 offset:1024
    v_mfma_f32_32x32x16_bf16 v[16:31], v[84:87], v[128:131], v[16:31]
    ds_read_b64_tr_b16 v[68:69], v113 offset:0
    ds_read_b64_tr_b16 v[70:71], v113 offset:1024
    v_mfma_f32_32x32x16_bf16 v[0:15], v[88:91], v[132:135], v[0:15]
    ds_read_b64_tr_b16 v[72:73], v112 offset:2048
    ds_read_b64_tr_b16 v[74:75], v112 offset:3072
    v_mfma_f32_32x32x16_bf16 v[16:31], v[92:95], v[132:135], v[16:31]
    s_waitcnt lgkmcnt(13)
    ds_read_b64_tr_b16 v[76:77], v113 offset:2048
    ds_read_b64_tr_b16 v[78:79], v113 offset:3072
    s_cmp_eq_u32 s63, 0
    s_cbranch_scc1 L22_osk
    s_add_u32 s49, s97, 8192
    buffer_load_dwordx4 v[192:195], v251, s[28:31], s49 offen sc1
    buffer_load_dwordx4 v[196:199], v251, s[28:31], s49 offen offset:1024 sc1
L22_osk:
    v_add_u32 v112, 122880, v114
    v_add_u32 v113, 122880, v115
    s_waitcnt lgkmcnt(8)
    v_mfma_f32_32x32x16_bf16 v[0:15], v[96:99], v[136:139], v[0:15]
    ds_read_b64_tr_b16 v[80:81], v112 offset:0
    ds_read_b64_tr_b16 v[82:83], v112 offset:1024
    v_mfma_f32_32x32x16_bf16 v[16:31], v[100:103], v[136:139], v[16:31]
    ds_read_b64_tr_b16 v[84:85], v113 offset:0
    ds_read_b64_tr_b16 v[86:87], v113 offset:1024
    v_mfma_f32_32x32x16_bf16 v[0:15], v[104:107], v[140:143], v[0:15]
    ds_read_b64_tr_b16 v[88:89], v112 offset:2048
    ds_read_b64_tr_b16 v[90:91], v112 offset:3072
    v_mfma_f32_32x32x16_bf16 v[16:31], v[108:111], v[140:143], v[16:31]
    s_waitcnt lgkmcnt(13)
    ds_read_b64_tr_b16 v[92:93], v113 offset:2048
    ds_read_b64_tr_b16 v[94:95], v113 offset:3072
    s_cmp_eq_u32 s63, 0
    s_cbranch_scc1 L23_osk
    s_add_u32 s49, s97, 12288
    buffer_load_dwordx4 v[200:203], v251, s[28:31], s49 offen sc1
    buffer_load_dwordx4 v[204:207], v251, s[28:31], s49 offen offset:1024 sc1
L23_osk:
    s_barrier
    v_add_u32 v112, 131072, v114
    v_add_u32 v113, 131072, v115
    s_waitcnt lgkmcnt(8)
    v_mfma_f32_32x32x16_bf16 v[0:15], v[64:67], v[144:147], v[0:15]
    ds_read_b64_tr_b16 v[96:97], v112 offset:0
    ds_read_b64_tr_b16 v[98:99], v112 offset:1024
    v_mfma_f32_32x32x16_bf16 v[16:31], v[68:71], v[144:147], v[16:31]
    ds_read_b64_tr_b16 v[100:101], v113 offset:0
    ds_read_b64_tr_b16 v[102:103], v113 offset:1024
    v_mfma_f32_32x32x16_bf16 v[0:15], v[72:75], v[148:151], v[0:15]
    ds_read_b64_tr_b16 v[104:105], v112 offset:2048
    ds_read_b64_tr_b16 v[106:107], v112 offset:3072
    v_mfma_f32_32x32x16_bf16 v[16:31], v[76:79], v[148:151], v[16:31]
    s_waitcnt lgkmcnt(13)
    ds_read_b64_tr_b16 v[108:109], v113 offset:2048
    ds_read_b64_tr_b16 v[110:111], v113 offset:3072
    s_cmp_lg_u32 s63, 0
    s_cbranch_scc1 L24_odone
    s_mov_b32 s6, 0
    s_mov_b32 s7, -1
    s_waitcnt vmcnt(0)
    v_cmp_eq_u32 vcc, s47, v244
    v_cmp_eq_u32 s[4:5], s48, v245
    s_nop 1
    s_and_b64 vcc, vcc, s[4:5]
    s_or_b64 vcc, vcc, s[6:7]
    s_cmp_eq_u64 vcc, -1
    s_cbranch_scc1 L25_ohit
    buffer_load_dwordx2 v[244:245], v246, s[28:31], s54 offen sc1
    s_branch L24_odone
L25_ohit:
    s_mov_b32 s63, 1
    s_lshl_b32 s49, s45, 1
    s_and_b32 s50, s40, 1
    s_add_u32 s49, s49, s50
    s_lshl_b32 s49, s49, 5
    v_and_b32 v118, 31, v250
    v_add_u32 v118, s49, v118
    v_lshlrev_b32 v117, 10, v118
    v_lshlrev_b32 v118, 2, v118
    v_add_u32 v118, 0x800000, v118
    buffer_load_dword v116, v118, s[28:31], 0 offen sc1
    s_add_u32 s49, s97, 0
    buffer_load_dwordx4 v[176:179], v251, s[28:31], s49 offen sc1
    buffer_load_dwordx4 v[180:183], v251, s[28:31], s49 offen offset:1024 sc1
    s_add_u32 s49, s97, 4096
    buffer_load_dwordx4 v[184:187], v251, s[28:31], s49 offen sc1
    buffer_load_dwordx4 v[188:191], v251, s[28:31], s49 offen offset:1024 sc1
    s_add_u32 s49, s97, 8192
    buffer_load_dwordx4 v[192:195], v251, s[28:31], s49 offen sc1
    buffer_load_dwordx4 v[196:199], v251, s[28:31], s49 offen offset:1024 sc1
    s_add_u32 s49, s97, 12288
    buffer_load_dwordx4 v[200:203], v251, s[28:31], s49 offen sc1
    buffer_load_dwordx4 v[204:207], v251, s[28:31], s49 offen offset:1024 sc1
L24_odone:
    s_cmp_eq_u32 s63, 0
    s_cbranch_scc1 L26_osk
    s_add_u32 s49, s97, 16384
    buffer_load_dwordx4 v[208:211], v251, s[28:31], s49 offen sc1
    buffer_load_dwordx4 v[212:215], v251, s[28:31], s49 offen offset:1024 sc1
L26_osk:
    v_add_u32 v112, 139264, v114
    v_add_u32 v113, 139264, v115
    s_waitcnt lgkmcnt(8)
    v_mfma_f32_32x32x16_bf16 v[0:15], v[80:83], v[152:155], v[0:15]
    ds_read_b64_tr_b16 v[64:65], v112 offset:0
    ds_read_b64_tr_b16 v[66:67], v112 offset:1024
    v_mfma_f32_32x32x16_bf16 v[16:31], v[84:87], v[152:155], v[16:31]
    ds_read_b64_tr_b16 v[68:69], v113 offset:0
    ds_read_b64_tr_b16 v[70:71], v113 offset:1024
    v_mfma_f32_32x32x16_bf16 v[0:15], v[88:91], v[156:159], v[0:15]
    ds_read_b64_tr_b16 v[72:73], v112 offset:2048
    ds_read_b64_tr_b16 v[74:75], v112 offset:3072
    v_mfma_f32_32x32x16_bf16 v[16:31], v[92:95], v[156:159], v[16:31]
    s_waitcnt lgkmcnt(13)
    ds_read_b64_tr_b16 v[76:77], v113 offset:2048
    ds_read_b64_tr_b16 v[78:79], v113 offset:3072
    s_cmp_eq_u32 s63, 0
    s_cbranch_scc1 L27_osk
    s_add_u32 s49, s97, 20480
    buffer_load_dwordx4 v[216:219], v251, s[28:31], s49 offen sc1
    buffer_load_dwordx4 v[220:223], v251, s[28:31], s49 offen offset:1024 sc1
L27_osk:
    s_barrier
    v_add_u32 v112, 147456, v114
    v_add_u32 v113, 147456, v115
    s_waitcnt lgkmcnt(8)
    v_mfma_f32_32x32x16_bf16 v[0:15], v[96:99], v[160:163], v[0:15]
    ds_read_b64_tr_b16 v[80:81], v112 offset:0
    ds_read_b64_tr_b16 v[82:83], v112 offset:1024
    v_mfma_f32_32x32x16_bf16 v[16:31], v[100:103], v[160:163], v[16:31]
    ds_read_b64_tr_b16 v[84:85], v113 offset:0
    ds_read_b64_tr_b16 v[86:87], v113 offset:1024
    v_mfma_f32_32x32x16_bf16 v[0:15], v[104:107], v[164:167], v[0:15]
    ds_read_b64_tr_b16 v[88:89], v112 offset:2048
    ds_read_b64_tr_b16 v[90:91], v112 offset:3072
    v_mfma_f32_32x32x16_bf16 v[16:31], v[108:111], v[164:167], v[16:31]
    s_waitcnt lgkmcnt(13)
    ds_read_b64_tr_b16 v[92:93], v113 offset:2048
    ds_read_b64_tr_b16 v[94:95], v113 offset:3072
    s_cmp_eq_u32 s63, 0
    s_cbranch_scc1 L28_osk
    s_add_u32 s49, s97, 24576
    buffer_load_dwordx4 v[224:227], v251, s[28:31], s49 offen sc1
    buffer_load_dwordx4 v[228:231], v251, s[28:31], s49 offen offset:1024 sc1
L28_osk:
    v_add_u32 v112, 155648, v114
    v_add_u32 v113, 155648, v115
    s_waitcnt lgkmcnt(8)
    v_mfma_f32_32x32x16_bf16 v[0:15], v[64:67], v[168:171], v[0:15]
    ds_read_b64_tr_b16 v[96:97], v112 offset:0
    ds_read_b64_tr_b16 v[98:99], v112 offset:1024
    v_mfma_f32_32x32x16_bf16 v[16:31], v[68:71], v[168:171], v[16:31]
    ds_read_b64_tr_b16 v[100:101], v113 offset:0
    ds_read_b64_tr_b16 v[102:103], v113 offset:1024
    v_mfma_f32_32x32x16_bf16 v[0:15], v[72:75], v[172:175], v[0:15]
    ds_read_b64_tr_b16 v[104:105], v112 offset:2048
    ds_read_b64_tr_b16 v[106:107], v112 offset:3072
    v_mfma_f32_32x32x16_bf16 v[16:31], v[76:79], v[172:175], v[16:31]
    s_waitcnt lgkmcnt(13)
    ds_read_b64_tr_b16 v[108:109], v113 offset:2048
    ds_read_b64_tr_b16 v[110:111], v113 offset:3072
    s_cmp_lg_u32 s63, 0
    s_cbranch_scc1 L29_odone
    s_mov_b32 s6, 0
    s_mov_b32 s7, -1
    s_mov_b32 s62, 0
L30_spin:
    s_waitcnt vmcnt(0)
L32_look:
    v_cmp_eq_u32 vcc, s47, v244
    v_cmp_eq_u32 s[4:5], s48, v245
    s_nop 1
    s_and_b64 vcc, vcc, s[4:5]
    s_or_b64 vcc, vcc, s[6:7]
    s_cmp_eq_u64 vcc, -1
    s_cbranch_scc1 L31_matched
    s_add_u32 s62, s62, 1
    s_cmp_ge_u32 s62, 131072
    s_cbranch_scc1 L31_matched
    buffer_load_dwordx2 v[244:245], v246, s[28:31], s54 offen sc1
    s_branch L30_spin
L31_matched:
    s_mov_b32 s63, 1
    s_lshl_b32 s49, s45, 1
    s_and_b32 s50, s40, 1
    s_add_u32 s49, s49, s50
    s_lshl_b32 s49, s49, 5
    v_and_b32 v118, 31, v250
    v_add_u32 v118, s49, v118
    v_lshlrev_b32 v117, 10, v118
    v_lshlrev_b32 v118, 2, v118
    v_add_u32 v118, 0x800000, v118
    buffer_load_dword v116, v118, s[28:31], 0 offen sc1
    s_add_u32 s49, s97, 0
    buffer_load_dwordx4 v[176:179], v251, s[28:31], s49 offen sc1
    buffer_load_dwordx4 v[180:183], v251, s[28:31], s49 offen offset:1024 sc1
    s_add_u32 s49, s97, 4096
    buffer_load_dwordx4 v[184:187], v251, s[28:31], s49 offen sc1
    buffer_load_dwordx4 v[188:191], v251, s[28:31], s49 offen offset:1024 sc1
    s_add_u32 s49, s97, 8192
    buffer_load_dwordx4 v[192:195], v251, s[28:31], s49 offen sc1
    buffer_load_dwordx4 v[196:199], v251, s[28:31], s49 offen offset:1024 sc1
    s_add_u32 s49, s97, 12288
    buffer_load_dwordx4 v[200:203], v251, s[28:31], s49 offen sc1
    buffer_load_dwordx4 v[204:207], v251, s[28:31], s49 offen offset:1024 sc1
    s_add_u32 s49, s97, 16384
    buffer_load_dwordx4 v[208:211], v251, s[28:31], s49 offen sc1
    buffer_load_dwordx4 v[212:215], v251, s[28:31], s49 offen offset:1024 sc1
    s_add_u32 s49, s97, 20480
    buffer_load_dwordx4 v[216:219], v251, s[28:31], s49 offen sc1
    buffer_load_dwordx4 v[220:223], v251, s[28:31], s49 offen offset:1024 sc1
    s_add_u32 s49, s97, 24576
    buffer_load_dwordx4 v[224:227], v251, s[28:31], s49 offen sc1
    buffer_load_dwordx4 v[228:231], v251, s[28:31], s49 offen offset:1024 sc1
L29_odone:
    s_cmp_eq_u32 s63, 0
    s_cbranch_scc1 L33_osk
    s_add_u32 s49, s97, 28672
    buffer_load_dwordx4 v[232:235], v251, s[28:31], s49 offen sc1
    buffer_load_dwordx4 v[236:239], v251, s[28:31], s49 offen offset:1024 sc1
L33_osk:
    s_barrier
    v_add_u32 v112, 0, v114
    v_add_u32 v113, 0, v115
    s_waitcnt lgkmcnt(8)
    s_waitcnt vmcnt(14)
    v_mfma_f32_32x32x16_bf16 v[32:47], v[80:83], v[176:179], 0
    ds_read_b64_tr_b16 v[64:65], v112 offset:0
    ds_read_b64_tr_b16 v[66:67], v112 offset:1024
    v_mfma_f32_32x32x16_bf16 v[48:63], v[84:87], v[176:179], 0
    ds_read_b64_tr_b16 v[68:69], v113 offset:0
    ds_read_b64_tr_b16 v[70:71], v113 offset:1024
    v_mfma_f32_32x32x16_bf16 v[32:47], v[88:91], v[180:183], v[32:47]
    ds_read_b64_tr_b16 v[72:73], v112 offset:2048
    ds_read_b64_tr_b16 v[74:75], v112 offset:3072
    v_mfma_f32_32x32x16_bf16 v[48:63], v[92:95], v[180:183], v[48:63]
    s_waitcnt lgkmcnt(13)
    ds_read_b64_tr_b16 v[76:77], v113 offset:2048
    ds_read_b64_tr_b16 v[78:79], v113 offset:3072
    v_add_u32 v112, 8192, v114
    v_add_u32 v113, 8192, v115
    s_waitcnt lgkmcnt(8)
    s_waitcnt vmcnt(12)
    v_mfma_f32_32x32x16_bf16 v[32:47], v[96:99], v[184:187], v[32:47]
    ds_read_b64_tr_b16 v[80:81], v112 offset:0
    ds_read_b64_tr_b16 v[82:83], v112 offset:1024
    v_mfma_f32_32x32x16_bf16 v[48:63], v[100:103], v[184:187], v[48:63]
    ds_read_b64_tr_b16 v[84:85], v113 offset:0
    ds_read_b64_tr_b16 v[86:87], v113 offset:1024
    v_mfma_f32_32x32x16_bf16 v[32:47], v[104:107], v[188:191], v[32:47]
    ds_read_b64_tr_b16 v[88:89], v112 offset:2048
    ds_read_b64_tr_b16 v[90:91], v112 offset:3072
    v_mfma_f32_32x32x16_bf16 v[48:63], v[108:111], v[188:191], v[48:63]
    s_waitcnt lgkmcnt(13)
    ds_read_b64_tr_b16 v[92:93], v113 offset:2048
    ds_read_b64_tr_b16 v[94:95], v113 offset:3072
    s_barrier
    v_add_u32 v112, 16384, v114
    v_add_u32 v113, 16384, v115
    s_waitcnt lgkmcnt(8)
    s_waitcnt vmcnt(10)
    v_mfma_f32_32x32x16_bf16 v[32:47], v[64:67], v[192:195], v[32:47]
    ds_read_b64_tr_b16 v[96:97], v112 offset:0
    ds_read_b64_tr_b16 v[98:99], v112 offset:1024
    v_mfma_f32_32x32x16_bf16 v[48:63], v[68:71], v[192:195], v[48:63]
    ds_read_b64_tr_b16 v[100:101], v113 offset:0
    ds_read_b64_tr_b16 v[102:103], v113 offset:1024
    v_mfma_f32_32x32x16_bf16 v[32:47], v[72:75], v[196:199], v[32:47]
    ds_read_b64_tr_b16 v[104:105], v112 offset:2048
    ds_read_b64_tr_b16 v[106:107], v112 offset:3072
    v_mfma_f32_32x32x16_bf16 v[48:63], v[76:79], v[196:199], v[48:63]
    s_waitcnt lgkmcnt(13)
    ds_read_b64_tr_b16 v[108:109], v113 offset:2048
    ds_read_b64_tr_b16 v[110:111], v113 offset:3072
    v_add_u32 v112, 24576, v114
    v_add_u32 v113, 24576, v115
    s_waitcnt lgkmcnt(8)
    s_waitcnt vmcnt(8)
    v_mfma_f32_32x32x16_bf16 v[32:47], v[80:83], v[200:203], v[32:47]
    ds_read_b64_tr_b16 v[64:65], v112 offset:0
    ds_read_b64_tr_b16 v[66:67], v112 offset:1024
    v_mfma_f32_32x32x16_bf16 v[48:63], v[84:87], v[200:203], v[48:63]
    ds_read_b64_tr_b16 v[68:69], v113 offset:0
    ds_read_b64_tr_b16 v[70:71], v113 offset:1024
    v_mfma_f32_32x32x16_bf16 v[32:47], v[88:91], v[204:207], v[32:47]
    ds_read_b64_tr_b16 v[72:73], v112 offset:2048
    ds_read_b64_tr_b16 v[74:75], v112 offset:3072
    v_mfma_f32_32x32x16_bf16 v[48:63], v[92:95], v[204:207], v[48:63]
    s_waitcnt lgkmcnt(13)
    ds_read_b64_tr_b16 v[76:77], v113 offset:2048
    ds_read_b64_tr_b16 v[78:79], v113 offset:3072
    s_barrier
    v_add_u32 v112, 32768, v114
    v_add_u32 v113, 32768, v115
    s_waitcnt lgkmcnt(8)
    s_waitcnt vmcnt(6)
    v_mfma_f32_32x32x16_bf16 v[32:47], v[96:99], v[208:211], v[32:47]
    ds_read_b64_tr_b16 v[80:81], v112 offset:0
    ds_read_b64_tr_b16 v[82:83], v112 offset:1024
    v_mfma_f32_32x32x16_bf16 v[48:63], v[100:103], v[208:211], v[48:63]
    ds_read_b64_tr_b16 v[84:85], v113 offset:0
    ds_read_b64_tr_b16 v[86:87], v113 offset:1024
    v_mfma_f32_32x32x16_bf16 v[32:47], v[104:107], v[212:215], v[32:47]
    ds_read_b64_tr_b16 v[88:89], v112 offset:2048
    ds_read_b64_tr_b16 v[90:91], v112 offset:3072
    v_mfma_f32_32x32x16_bf16 v[48:63], v[108:111], v[212:215], v[48:63]
    s_waitcnt lgkmcnt(13)
    ds_read_b64_tr_b16 v[92:93], v113 offset:2048
    ds_read_b64_tr_b16 v[94:95], v113 offset:3072
    v_add_u32 v112, 40960, v114
    v_add_u32 v113, 40960, v115
    s_waitcnt lgkmcnt(8)
    s_waitcnt vmcnt(4)
    v_mfma_f32_32x32x16_bf16 v[32:47], v[64:67], v[216:219], v[32:47]
    ds_read_b64_tr_b16 v[96:97], v112 offset:0
    ds_read_b64_tr_b16 v[98:99], v112 offset:1024
    v_mfma_f32_32x32x16_bf16 v[48:63], v[68:71], v[216:219], v[48:63]
    ds_read_b64_tr_b16 v[100:101], v113 offset:0
    ds_read_b64_tr_b16 v[102:103], v113 offset:1024
    v_mfma_f32_32x32x16_bf16 v[32:47], v[72:75], v[220:223], v[32:47]
    ds_read_b64_tr_b16 v[104:105], v112 offset:2048
    ds_read_b64_tr_b16 v[106:107], v112 offset:3072
    v_mfma_f32_32x32x16_bf16 v[48:63], v[76:79], v[220:223], v[48:63]
    s_waitcnt lgkmcnt(13)
    ds_read_b64_tr_b16 v[108:109], v113 offset:2048
    ds_read_b64_tr_b16 v[110:111], v113 offset:3072
    s_waitcnt lgkmcnt(8)
    s_waitcnt vmcnt(2)
    v_mfma_f32_32x32x16_bf16 v[32:47], v[80:83], v[224:227], v[32:47]
    v_mfma_f32_32x32x16_bf16 v[48:63], v[84:87], v[224:227], v[48:63]
    v_mfma_f32_32x32x16_bf16 v[32:47], v[88:91], v[228:231], v[32:47]
    v_mfma_f32_32x32x16_bf16 v[48:63], v[92:95], v[228:231], v[48:63]
    s_waitcnt lgkmcnt(0)
    s_waitcnt vmcnt(0)
    v_mfma_f32_32x32x16_bf16 v[32:47], v[96:99], v[232:235], v[32:47]
    v_mfma_f32_32x32x16_bf16 v[48:63], v[100:103], v[232:235], v[48:63]
    v_mfma_f32_32x32x16_bf16 v[32:47], v[104:107], v[236:239], v[32:47]
    v_mfma_f32_32x32x16_bf16 v[48:63], v[108:111], v[236:239], v[48:63]
    s_nop 15
    v_mov_b32 v114, v116
    v_mov_b32 v115, v116
    s_lshl_b32 s49, s40, 12
    v_add_u32 v112, s49, v251
    s_xor_b32 s49, s49, 0x2000
    v_add_u32 v113, s49, v251
    s_cmp_ge_u32 s40, 2
    s_cbranch_scc1 L34_k1
    v_pk_add_f32 v[48:49], v[48:49], v[16:17] neg_lo:[0,1] neg_hi:[0,1]
    v_pk_add_f32 v[50:51], v[50:51], v[18:19] neg_lo:[0,1] neg_hi:[0,1]
    v_pk_add_f32 v[52:53], v[52:53], v[20:21] neg_lo:[0,1] neg_hi:[0,1]
    v_pk_add_f32 v[54:55], v[54:55], v[22:23] neg_lo:[0,1] neg_hi:[0,1]
    v_pk_add_f32 v[56:57], v[56:57], v[24:25] neg_lo:[0,1] neg_hi:[0,1]
    v_pk_add_f32 v[58:59], v[58:59], v[26:27] neg_lo:[0,1] neg_hi:[0,1]
    v_pk_add_f32 v[60:61], v[60:61], v[28:29] neg_lo:[0,1] neg_hi:[0,1]
    v_pk_add_f32 v[62:63], v[62:63], v[30:31] neg_lo:[0,1] neg_hi:[0,1]
    v_pk_fma_f32 v[16:17], v[114:115], v[48:49], v[16:17]
    v_pk_fma_f32 v[18:19], v[114:115], v[50:51], v[18:19]
    v_pk_fma_f32 v[20:21], v[114:115], v[52:53], v[20:21]
    v_pk_fma_f32 v[22:23], v[114:115], v[54:55], v[22:23]
    v_pk_fma_f32 v[24:25], v[114:115], v[56:57], v[24:25]
    v_pk_fma_f32 v[26:27], v[114:115], v[58:59], v[26:27]
    v_pk_fma_f32 v[28:29], v[114:115], v[60:61], v[28:29]
    v_pk_fma_f32 v[30:31], v[114:115], v[62:63], v[30:31]
    ds_write_b128 v112, v[16:19] offset:0
    ds_write_b128 v112, v[20:23] offset:1024
    ds_write_b128 v112, v[24:27] offset:2048
    ds_write_b128 v112, v[28:31] offset:3072
    v_pk_add_f32 v[32:33], v[32:33], v[0:1] neg_lo:[0,1] neg_hi:[0,1]
    v_pk_add_f32 v[34:35], v[34:35], v[2:3] neg_lo:[0,1] neg_hi:[0,1]
    v_pk_add_f32 v[36:37], v[36:37], v[4:5] neg_lo:[0,1] neg_hi:[0,1]
    v_pk_add_f32 v[38:39], v[38:39], v[6:7] neg_lo:[0,1] neg_hi:[0,1]
    v_pk_add_f32 v[40:41], v[40:41], v[8:9] neg_lo:[0,1] neg_hi:[0,1]
    v_pk_add_f32 v[42:43], v[42:43], v[10:11] neg_lo:[0,1] neg_hi:[0,1]
    v_pk_add_f32 v[44:45], v[44:45], v[12:13] neg_lo:[0,1] neg_hi:[0,1]
    v_pk_add_f32 v[46:47], v[46:47], v[14:15] neg_lo:[0,1] neg_hi:[0,1]
    v_pk_fma_f32 v[0:1], v[114:115], v[32:33], v[0:1]
    v_pk_fma_f32 v[2:3], v[114:115], v[34:35], v[2:3]
    v_pk_fma_f32 v[4:5], v[114:115], v[36:37], v[4:5]
    v_pk_fma_f32 v[6:7], v[114:115], v[38:39], v[6:7]
    v_pk_fma_f32 v[8:9], v[114:115], v[40:41], v[8:9]
    v_pk_fma_f32 v[10:11], v[114:115], v[42:43], v[10:11]
    v_pk_fma_f32 v[12:13], v[114:115], v[44:45], v[12:13]
    v_pk_fma_f32 v[14:15], v[114:115], v[46:47], v[14:15]
    s_branch L35_kd
L34_k1:
    v_pk_add_f32 v[32:33], v[32:33], v[0:1] neg_lo:[0,1] neg_hi:[0,1]
    v_pk_add_f32 v[34:35], v[34:35], v[2:3] neg_lo:[0,1] neg_hi:[0,1]
    v_pk_add_f32 v[36:37], v[36:37], v[4:5] neg_lo:[0,1] neg_hi:[0,1]
    v_pk_add_f32 v[38:39], v[38:39], v[6:7] neg_lo:[0,1] neg_hi:[0,1]
    v_pk_add_f32 v[40:41], v[40:41], v[8:9] neg_lo:[0,1] neg_hi:[0,1]
    v_pk_add_f32 v[42:43], v[42:43], v[10:11] neg_lo:[0,1] neg_hi:[0,1]
    v_pk_add_f32 v[44:45], v[44:45], v[12:13] neg_lo:[0,1] neg_hi:[0,1]
    v_pk_add_f32 v[46:47], v[46:47], v[14:15] neg_lo:[0,1] neg_hi:[0,1]
    v_pk_fma_f32 v[0:1], v[114:115], v[32:33], v[0:1]
    v_pk_fma_f32 v[2:3], v[114:115], v[34:35], v[2:3]
    v_pk_fma_f32 v[4:5], v[114:115], v[36:37], v[4:5]
    v_pk_fma_f32 v[6:7], v[114:115], v[38:39], v[6:7]
    v_pk_fma_f32 v[8:9], v[114:115], v[40:41], v[8:9]
    v_pk_fma_f32 v[10:11], v[114:115], v[42:43], v[10:11]
    v_pk_fma_f32 v[12:13], v[114:115], v[44:45], v[12:13]
    v_pk_fma_f32 v[14:15], v[114:115], v[46:47], v[14:15]
    ds_write_b128 v112, v[0:3] offset:0
    ds_write_b128 v112, v[4:7] offset:1024
    ds_write_b128 v112, v[8:11] offset:2048
    ds_write_b128 v112, v[12:15] offset:3072
    v_pk_add_f32 v[48:49], v[48:49], v[16:17] neg_lo:[0,1] neg_hi:[0,1]
    v_pk_add_f32 v[50:51], v[50:51], v[18:19] neg_lo:[0,1] neg_hi:[0,1]
    v_pk_add_f32 v[52:53], v[52:53], v[20:21] neg_lo:[0,1] neg_hi:[0,1]
    v_pk_add_f32 v[54:55], v[54:55], v[22:23] neg_lo:[0,1] neg_hi:[0,1]
    v_pk_add_f32 v[56:57], v[56:57], v[24:25] neg_lo:[0,1] neg_hi:[0,1]
    v_pk_add_f32 v[58:59], v[58:59], v[26:27] neg_lo:[0,1] neg_hi:[0,1]
    v_pk_add_f32 v[60:61], v[60:61], v[28:29] neg_lo:[0,1] neg_hi:[0,1]
    v_pk_add_f32 v[62:63], v[62:63], v[30:31] neg_lo:[0,1] neg_hi:[0,1]
    v_pk_fma_f32 v[16:17], v[114:115], v[48:49], v[16:17]
    v_pk_fma_f32 v[18:19], v[114:115], v[50:51], v[18:19]
    v_pk_fma_f32 v[20:21], v[114:115], v[52:53], v[20:21]
    v_pk_fma_f32 v[22:23], v[114:115], v[54:55], v[22:23]
    v_pk_fma_f32 v[24:25], v[114:115], v[56:57], v[24:25]
    v_pk_fma_f32 v[26:27], v[114:115], v[58:59], v[26:27]
    v_pk_fma_f32 v[28:29], v[114:115], v[60:61], v[28:29]
    v_pk_fma_f32 v[30:31], v[114:115], v[62:63], v[30:31]
    s_waitcnt lgkmcnt(0)
    v_pk_mov_b32 v[0:1], v[16:17], v[16:17] op_sel:[0,1]
    v_pk_mov_b32 v[2:3], v[18:19], v[18:19] op_sel:[0,1]
    v_pk_mov_b32 v[4:5], v[20:21], v[20:21] op_sel:[0,1]
    v_pk_mov_b32 v[6:7], v[22:23], v[22:23] op_sel:[0,1]
    v_pk_mov_b32 v[8:9], v[24:25], v[24:25] op_sel:[0,1]
    v_pk_mov_b32 v[10:11], v[26:27], v[26:27] op_sel:[0,1]
    v_pk_mov_b32 v[12:13], v[28:29], v[28:29] op_sel:[0,1]
    v_pk_mov_b32 v[14:15], v[30:31], v[30:31] op_sel:[0,1]
L35_kd:
    s_waitcnt lgkmcnt(0)
    s_barrier
    ds_read_b128 v[32:35], v113 offset:0
    ds_read_b128 v[36:39], v113 offset:1024
    ds_read_b128 v[40:43], v113 offset:2048
    ds_read_b128 v[44:47], v113 offset:3072
    s_lshl_b32 s49, s46, 7
    s_lshr_b32 s50, s40, 1
    s_lshl_b32 s50, s50, 6
    s_add_u32 s49, s49, s50
    v_lshrrev_b32 v118, 5, v250
    v_lshlrev_b32 v118, 4, v118
    v_add_u32 v117, v117, v118
    s_waitcnt lgkmcnt(0)
    v_pk_add_f32 v[0:1], v[0:1], v[32:33]
    v_pk_add_f32 v[2:3], v[2:3], v[34:35]
    v_pk_add_f32 v[4:5], v[4:5], v[36:37]
    v_pk_add_f32 v[6:7], v[6:7], v[38:39]
    v_pk_add_f32 v[8:9], v[8:9], v[40:41]
    v_pk_add_f32 v[10:11], v[10:11], v[42:43]
    v_pk_add_f32 v[12:13], v[12:13], v[44:45]
    v_pk_add_f32 v[14:15], v[14:15], v[46:47]
    v_cvt_pk_bf16_f32 v32, v0, v1
    v_cvt_pk_bf16_f32 v33, v2, v3
    v_cvt_pk_bf16_f32 v34, v4, v5
    v_cvt_pk_bf16_f32 v35, v6, v7
    v_cvt_pk_bf16_f32 v36, v8, v9
    v_cvt_pk_bf16_f32 v37, v10, v11
    v_cvt_pk_bf16_f32 v38, v12, v13
    v_cvt_pk_bf16_f32 v39, v14, v15
    s_nop 1
    v_permlane32_swap_b32 v32, v34
    v_permlane32_swap_b32 v33, v35
    s_nop 1
    v_permlane32_swap_b32 v36, v38
    v_permlane32_swap_b32 v37, v39
    buffer_store_dwordx4 v[32:35], v117, s[32:35], s49 offen offset:0
    buffer_store_dwordx4 v[36:39], v117, s[32:35], s49 offen offset:32
    s_or_b32 s49, s2, s40
    s_cmp_lg_u32 s49, 0
    s_cbranch_scc1 L36_noep
    s_mov_b32 s49, 0xf00000
    s_mov_b64 exec, 1
    buffer_store_dwordx2 v[248:249], v247, s[28:31], s49 offen sc1
    s_mov_b64 exec, -1
L36_noep:
gated_mix__mha_block__dense_activation_silu__prompt_kernel_exit:
    s_endpgm
L16_slow:
    v_subrev_u32 v108, 65536, v108
    v_subrev_u32 v109, 65536, v109
    v_mov_b32 v110, 0xff800000
    s_mov_b32 s53, 0
    v_mov_b32 v40, 0
    v_mov_b32 v41, 0
    v_mov_b32 v42, 0
    v_mov_b32 v43, 0
    v_mov_b32 v44, 0
    v_mov_b32 v45, 0
    v_mov_b32 v46, 0
    v_mov_b32 v47, 0
    v_mov_b32 v48, 0
    v_mov_b32 v49, 0
    v_mov_b32 v50, 0
    v_mov_b32 v51, 0
    v_mov_b32 v52, 0
    v_mov_b32 v53, 0
    v_mov_b32 v54, 0
    v_mov_b32 v55, 0
L37_sloop:
    ds_read_b128 v[60:63], v108
    s_mov_b64 exec, s[60:61]
    ds_read_b128 v[76:79], v109
    ds_read_b128 v[92:95], v109 offset:512
    s_mov_b64 exec, -1
    s_waitcnt lgkmcnt(0)
    v_mfma_f32_32x32x16_bf16 v[0:15], v[60:63], v[56:59], 0
    s_nop 15
    s_nop 7
    v_max3_f32 v111, v0, v1, v110
    v_max3_f32 v111, v2, v3, v111
    v_max3_f32 v111, v4, v5, v111
    v_max3_f32 v111, v6, v7, v111
    v_max3_f32 v111, v8, v9, v111
    v_max3_f32 v111, v10, v11, v111
    v_max3_f32 v111, v12, v13, v111
    v_max3_f32 v111, v14, v15, v111
    v_mov_b32 v112, v111
    v_mov_b32 v113, v111
    s_nop 1
    v_permlane32_swap_b32 v112, v113
    s_nop 1
    v_max_f32 v111, v112, v113
    v_sub_f32 v112, v110, v111
    v_exp_f32 v112, v112
    v_mov_b32 v110, v111
    v_sub_f32 v0, v0, v111
    v_sub_f32 v1, v1, v111
    v_sub_f32 v2, v2, v111
    v_sub_f32 v3, v3, v111
    v_sub_f32 v4, v4, v111
    v_sub_f32 v5, v5, v111
    v_sub_f32 v6, v6, v111
    v_sub_f32 v7, v7, v111
    v_sub_f32 v8, v8, v111
    v_sub_f32 v9, v9, v111
    v_sub_f32 v10, v10, v111
    v_sub_f32 v11, v11, v111
    v_sub_f32 v12, v12, v111
    v_sub_f32 v13, v13, v111
    v_sub_f32 v14, v14, v111
    v_sub_f32 v15, v15, v111
    v_exp_f32 v0, v0
    v_exp_f32 v1, v1
    v_exp_f32 v2, v2
    v_exp_f32 v3, v3
    v_exp_f32 v4, v4
    v_exp_f32 v5, v5
    v_exp_f32 v6, v6
    v_exp_f32 v7, v7
    v_exp_f32 v8, v8
    v_exp_f32 v9, v9
    v_exp_f32 v10, v10
    v_exp_f32 v11, v11
    v_exp_f32 v12, v12
    v_exp_f32 v13, v13
    v_exp_f32 v14, v14
    v_exp_f32 v15, v15
    v_mul_f32 v40, v40, v112
    v_mul_f32 v41, v41, v112
    v_mul_f32 v42, v42, v112
    v_mul_f32 v43, v43, v112
    v_mul_f32 v44, v44, v112
    v_mul_f32 v45, v45, v112
    v_mul_f32 v46, v46, v112
    v_mul_f32 v47, v47, v112
    v_mul_f32 v48, v48, v112
    v_cvt_pk_bf16_f32 v32, v0, v1
    v_cvt_pk_bf16_f32 v33, v2, v3
    v_cvt_pk_bf16_f32 v34, v4, v5
    v_cvt_pk_bf16_f32 v35, v6, v7
    v_cvt_pk_bf16_f32 v36, v8, v9
    v_cvt_pk_bf16_f32 v37, v10, v11
    v_cvt_pk_bf16_f32 v38, v12, v13
    v_cvt_pk_bf16_f32 v39, v14, v15
    s_nop 1
    v_mfma_f32_32x32x16_bf16 v[40:55], v[76:79], v[32:35], v[40:55]
    v_mfma_f32_32x32x16_bf16 v[40:55], v[92:95], v[36:39], v[40:55]
    s_nop 15
    s_nop 7
    v_add_u32 v108, 1024, v108
    v_add_u32 v109, 1024, v109
    s_add_u32 s53, s53, 1
    s_cmp_lt_u32 s53, 64
    s_cbranch_scc1 L37_sloop
    s_branch L15_ok
L11_jobs:
    s_cmp_lt_u32 s40, 4
    s_cbranch_scc0 L38_ld
    s_cmp_eq_u32 s53, 7
    s_cbranch_scc0 L39_nf
    s_setprio 0
L39_nf:
    s_cmp_eq_u32 s53, 1
    s_cbranch_scc0 L40_c2
    s_cmp_eq_u32 s42, 15
    s_cbranch_scc1 L12_n5
    s_lshl_b32 s49, s41, 2
    s_add_u32 s49, s49, s40
    s_mul_i32 s50, s49, 90112
    s_mul_i32 s49, s42, 6144
    s_add_u32 s50, s50, s49
    s_add_u32 s50, s50, 0x900000
    s_add_u32 s49, s50, 0
    buffer_store_dwordx4 v[212:215], v251, s[28:31], s49 offen sc1
    s_add_u32 s49, s50, 1024
    buffer_store_dwordx4 v[216:219], v251, s[28:31], s49 offen sc1
    s_add_u32 s49, s50, 2048
    buffer_store_dwordx4 v[220:223], v251, s[28:31], s49 offen sc1
    s_add_u32 s49, s50, 3072
    buffer_store_dwordx4 v[224:227], v251, s[28:31], s49 offen sc1
    s_cmp_eq_u32 s42, 14
    s_cbranch_scc1 L12_n5
    s_add_u32 s49, s50, 4096
    buffer_store_dwordx4 v[228:231], v251, s[28:31], s49 offen sc1
    s_add_u32 s49, s50, 5120
    buffer_store_dwordx4 v[232:235], v251, s[28:31], s49 offen sc1
    s_branch L12_n5
L40_c2:
    s_cmp_eq_u32 s53, 2
    s_cbranch_scc0 L41_c3
    s_waitcnt vmcnt(0)
    s_barrier
    s_cmp_eq_u32 s42, 15
    s_cbranch_scc1 L12_n5
    s_lshl_b32 s49, s41, 2
    s_add_u32 s49, s49, s40
    s_lshl_b32 s49, s49, 4
    s_add_u32 s49, s49, s42
    s_lshl_b32 s49, s49, 3
    s_add_u32 s49, s49, 0xf04000
    s_waitcnt vmcnt(0)
    s_mov_b64 exec, 1
    buffer_store_dwordx2 v[248:249], v247, s[28:31], s49 offen sc1
    s_mov_b64 exec, -1
    s_branch L12_n5
L41_c3:
    s_cmp_eq_u32 s53, 3
    s_cbranch_scc0 L42_c4
    s_lshl_b32 s56, s45, 1
    s_and_b32 s49, s40, 1
    s_add_u32 s56, s56, s49
    s_lshl_b32 s56, s56, 7
    s_add_u32 s56, s56, 0xf04000
    buffer_load_dwordx2 v[244:245], v246, s[28:31], s56 offen sc1
    s_branch L12_n5
L42_c4:
    s_cmp_eq_u32 s53, 4
    s_cbranch_scc0 L43_c5
    s_mov_b32 s6, 0xffff8000
    s_mov_b32 s7, -1
    s_mov_b32 s62, 0
L45_spin:
    s_waitcnt vmcnt(0)
L47_look:
    v_cmp_eq_u32 vcc, s47, v244
    v_cmp_eq_u32 s[4:5], s48, v245
    s_nop 1
    s_and_b64 vcc, vcc, s[4:5]
    s_or_b64 vcc, vcc, s[6:7]
    s_cmp_eq_u64 vcc, -1
    s_cbranch_scc1 L46_matched
    s_add_u32 s62, s62, 1
    s_cmp_ge_u32 s62, 131072
    s_cbranch_scc1 L46_matched
    buffer_load_dwordx2 v[244:245], v246, s[28:31], s56 offen sc1
    s_branch L45_spin
L46_matched:
    s_lshl_b32 s49, s46, 1
    s_lshr_b32 s50, s40, 1
    s_add_u32 s49, s49, s50
    s_mul_i32 s49, s49, 5504
    s_lshl_b32 s50, s45, 1
    s_and_b32 s51, s40, 1
    s_add_u32 s50, s50, s51
    s_mul_i32 s50, s50, 90112
    s_add_u32 s50, s50, s49
    s_add_u32 s50, s50, 0x900000
    v_min_u32 v114, 42, v250
    v_lshlrev_b32 v241, 7, v114
    buffer_load_dword v240, v241, s[28:31], s50 offen sc1
    s_branch L12_n5
L43_c5:
    s_cmp_eq_u32 s53, 5
    s_cbranch_scc0 L44_c6
    s_lshl_b32 s49, s45, 1
    s_and_b32 s50, s40, 1
    s_add_u32 s49, s49, s50
    s_lshr_b32 s50, s40, 1
    s_lshl_b32 s50, s50, 11
    s_mul_i32 s96, s49, 90112
    s_add_u32 s96, s96, s50
    s_add_u32 s96, s96, 0x900000
    s_lshl_b32 s97, s49, 15
    s_add_u32 s97, s97, s50
    s_add_u32 s97, s97, 0x600000
    s_add_u32 s49, s96, 0
    buffer_load_dwordx4 v[120:123], v251, s[28:31], s49 offen sc1
    buffer_load_dwordx4 v[124:127], v251, s[28:31], s49 offen offset:1024 sc1
    s_add_u32 s49, s96, 4096
    buffer_load_dwordx4 v[128:131], v251, s[28:31], s49 offen sc1
    buffer_load_dwordx4 v[132:135], v251, s[28:31], s49 offen offset:1024 sc1
    s_add_u32 s49, s96, 8192
    buffer_load_dwordx4 v[136:139], v251, s[28:31], s49 offen sc1
    buffer_load_dwordx4 v[140:143], v251, s[28:31], s49 offen offset:1024 sc1
    s_add_u32 s49, s96, 12288
    buffer_load_dwordx4 v[144:147], v251, s[28:31], s49 offen sc1
    buffer_load_dwordx4 v[148:151], v251, s[28:31], s49 offen offset:1024 sc1
    s_add_u32 s49, s96, 16384
    buffer_load_dwordx4 v[152:155], v251, s[28:31], s49 offen sc1
    buffer_load_dwordx4 v[156:159], v251, s[28:31], s49 offen offset:1024 sc1
    s_branch L12_n5
L44_c6:
    s_cmp_eq_u32 s53, 6
    s_cbranch_scc0 L48_c7
    s_add_u32 s49, s96, 20480
    buffer_load_dwordx4 v[160:163], v251, s[28:31], s49 offen sc1
    buffer_load_dwordx4 v[164:167], v251, s[28:31], s49 offen offset:1024 sc1
    s_add_u32 s49, s96, 24576
    buffer_load_dwordx4 v[168:171], v251, s[28:31], s49 offen sc1
    buffer_load_dwordx4 v[172:175], v251, s[28:31], s49 offen offset:1024 sc1
    s_add_u32 s49, s96, 28672
    buffer_load_dwordx4 v[176:179], v251, s[28:31], s49 offen sc1
    buffer_load_dwordx4 v[180:183], v251, s[28:31], s49 offen offset:1024 sc1
    s_add_u32 s49, s96, 32768
    buffer_load_dwordx4 v[184:187], v251, s[28:31], s49 offen sc1
    buffer_load_dwordx4 v[188:191], v251, s[28:31], s49 offen offset:1024 sc1
    s_add_u32 s49, s96, 36864
    buffer_load_dwordx4 v[192:195], v251, s[28:31], s49 offen sc1
    buffer_load_dwordx4 v[196:199], v251, s[28:31], s49 offen offset:1024 sc1
    s_branch L12_n5
L48_c7:
    s_add_u32 s49, s96, 40960
    buffer_load_dwordx4 v[200:203], v251, s[28:31], s49 offen sc1
    buffer_load_dwordx4 v[204:207], v251, s[28:31], s49 offen offset:1024 sc1
    s_add_u32 s49, s96, 45056
    buffer_load_dwordx4 v[208:211], v251, s[28:31], s49 offen sc1
    buffer_load_dwordx4 v[212:215], v251, s[28:31], s49 offen offset:1024 sc1
    s_add_u32 s49, s96, 49152
    buffer_load_dwordx4 v[216:219], v251, s[28:31], s49 offen sc1
    buffer_load_dwordx4 v[220:223], v251, s[28:31], s49 offen offset:1024 sc1
    s_add_u32 s49, s96, 53248
    buffer_load_dwordx4 v[224:227], v251, s[28:31], s49 offen sc1
    buffer_load_dwordx4 v[228:231], v251, s[28:31], s49 offen offset:1024 sc1
    s_add_u32 s49, s96, 57344
    buffer_load_dwordx4 v[232:235], v251, s[28:31], s49 offen sc1
    buffer_load_dwordx4 v[236:239], v251, s[28:31], s49 offen offset:1024 sc1
    s_branch L12_n5
L38_ld:
    s_cmp_eq_u32 s53, 1
    s_cbranch_scc0 L49_j6
    s_waitcnt vmcnt(0)
    s_barrier
    s_branch L12_n5
L49_j6:
    s_cmp_eq_u32 s53, 4
    s_cbranch_scc0 L50_j7
    s_lshr_b32 s49, s2, 3
    s_lshl_b32 s49, s49, 2
    s_add_u32 s49, s49, s63
    v_min_u32 v114, 42, v250
    v_lshlrev_b32 v241, 7, v114
    s_mul_i32 s50, s49, 11008
    buffer_load_dword v240, v241, s[20:23], s50 offen
    s_add_u32 s50, s50, 5504
    buffer_load_dword v240, v241, s[20:23], s50 offen
    v_and_b32 v114, 31, v250
    v_lshlrev_b32 v115, 7, v114
    s_lshl_b32 s50, s49, 12
    buffer_load_dword v240, v115, s[24:27], s50 offen
    s_branch L12_n5
L50_j7:
    v_lshrrev_b32 v114, 3, v250
    s_lshl_b32 s49, s63, 4
    v_add_u32 v114, s49, v114
    v_lshlrev_b32 v114, 10, v114
    v_bfe_u32 v115, v250, 4, 1
    v_lshlrev_b32 v115, 2, v115
    v_and_b32 v116, 7, v250
    v_xor_b32 v115, v115, v116
    v_lshlrev_b32 v115, 4, v115
    v_add_u32 v114, v114, v115
    s_lshl_b32 s49, s46, 7
    v_add_u32 v242, s49, v114
    v_add_u32 v243, 8192, v242
    s_lshl_b32 s98, s63, 11
    s_add_u32 m0, s98, 131072
    s_mov_b32 s55, 0
    buffer_load_dwordx4 v242, s[20:23], s55 offen lds
    s_add_u32 m0, s98, 132096
    s_nop 0
    buffer_load_dwordx4 v243, s[20:23], s55 offen lds
    s_add_u32 m0, s98, 139264
    s_mov_b32 s55, 65536
    buffer_load_dwordx4 v242, s[20:23], s55 offen lds
    s_add_u32 m0, s98, 140288
    s_nop 0
    buffer_load_dwordx4 v243, s[20:23], s55 offen lds
    s_add_u32 m0, s98, 147456
    s_mov_b32 s55, 131072
    buffer_load_dwordx4 v242, s[20:23], s55 offen lds
    s_add_u32 m0, s98, 148480
    s_nop 0
    buffer_load_dwordx4 v243, s[20:23], s55 offen lds
    s_add_u32 m0, s98, 155648
    s_mov_b32 s55, 196608
    buffer_load_dwordx4 v242, s[20:23], s55 offen lds
    s_add_u32 m0, s98, 156672
    s_nop 0
    buffer_load_dwordx4 v243, s[20:23], s55 offen lds
    s_branch L12_n5
.section .rodata,"a"
.p2align 6
.amdhsa_kernel gated_mix__mha_block__dense_activation_silu__prompt_kernel
  .amdhsa_next_free_vgpr 256
  .amdhsa_next_free_sgpr 102
  .amdhsa_accum_offset 256
  .amdhsa_group_segment_fixed_size 0
  .amdhsa_kernarg_size 80
  .amdhsa_user_sgpr_count 2
  .amdhsa_user_sgpr_kernarg_segment_ptr 1
  .amdhsa_system_sgpr_workgroup_id_x 1
  .amdhsa_float_denorm_mode_32 3
.end_amdhsa_kernel
```
